```python
import torch

def _softmax(x, axis=-1):
    return torch.softmax(x, dim=axis)
def _gelu(x):
    return torch.nn.functional.gelu(x, approximate="tanh")
def _silu(x):
    return torch.nn.functional.silu(x)
def _sigmoid(x):
    return torch.sigmoid(x)
def _layernorm(x, axis=-1, eps=1e-5):
    m = x.mean(dim=axis, keepdim=True)
    v = x.var(dim=axis, keepdim=True, unbiased=False)
    return (x - m) / torch.sqrt(v + eps)
def _scatter_add(tgt, idx, src, axis=0):
    return tgt.clone().index_add_(axis, idx, src)
def _segment_sum(src, seg, n):
    out = torch.zeros((n,) + src.shape[1:], dtype=src.dtype)
    return out.index_add_(0, seg, src)
def _pad(x, pw):
    flat = tuple(v for pair in reversed(pw) for v in pair)
    return torch.nn.functional.pad(x, flat)

kernel_name = 'gated_mix__linear_attn_block__ssm_conv_s4d__prompt'

def setup_inputs():

    _w = (lambda a: (lambda t: t.to(torch.bfloat16) if t.is_floating_point() else t)(torch.as_tensor(a)))
    def _A_setup():
        B, S, D = 1, 2048, 640
        return {
            "x": _w((lambda *s: torch.randn(*s, dtype=torch.bfloat16) * 0.05)(B, S, D)),
            "wqkv": _w((lambda *s: torch.randn(*s, dtype=torch.bfloat16) * 0.8)(D, 3 * D)),
            "wo": _w((lambda *s: torch.randn(*s, dtype=torch.bfloat16) * 0.05)(D, D)),
        }
    _A_in = _A_setup()

    def _B_setup():
        Bsz, L, D, N = 1, 2048, 640, 128
        return {
            "u": _w((lambda *s: torch.randn(*s, dtype=torch.bfloat16) * 0.05)(Bsz, L, D)),
            "log_A_real": _w((lambda *s: torch.randn(*s, dtype=torch.bfloat16) * 6.4)(D, N) * 0.5),
            "A_imag": _w((lambda *s: torch.randn(*s, dtype=torch.bfloat16) * 0.1)(D, N) * 3.14),
            "C_real": _w((lambda *s: torch.randn(*s, dtype=torch.bfloat16) * 0.2)(D, N) / N ** 0.5),
            "C_imag": _w((lambda *s: torch.randn(*s, dtype=torch.bfloat16) * 0.2)(D, N) / N ** 0.5),
            "log_dt": _w((lambda *s: torch.randn(*s, dtype=torch.bfloat16) * 0.1)(D) * 0.5 - 4.0),
            "D_skip": _w((lambda *s: torch.randn(*s, dtype=torch.bfloat16) * 0.1)(D)),
        }
    _B_in = _B_setup()

    return {
        "A_x": _A_in["x"],
        "A_wqkv": _A_in["wqkv"],
        "A_wo": _A_in["wo"],
        "B_u": _B_in["u"],
        "B_log_A_real": _B_in["log_A_real"],
        "B_A_imag": _B_in["A_imag"],
        "B_C_real": _B_in["C_real"],
        "B_C_imag": _B_in["C_imag"],
        "B_log_dt": _B_in["log_dt"],
        "B_D_skip": _B_in["D_skip"],
        "gate_w": _w((lambda *s: torch.randn(*s, dtype=torch.bfloat16) * 0.05)(640) * 16.0),
    }

def reference(A_x, A_wqkv, A_wo, B_u, B_log_A_real, B_A_imag, B_C_real, B_C_imag, B_log_dt, B_D_skip, gate_w):
    def _A_ref(x, wqkv, wo):
        B, S, D = x.shape
        H = 32; Dh = D // H
        qkv = (lambda x, *d: x.permute(*d))((x @ wqkv).reshape(B, S, 3, H, Dh), 2, 0, 3, 1, 4)
        q, k, v = qkv[0], qkv[1], qkv[2]
        phi = lambda t: torch.where(t > 0, t + 1, torch.exp(t)) + 1e-6
        pq, pk = phi(q), phi(k)
        kv = torch.einsum("bhsd,bhse->bhde", pk, v)
        z = torch.einsum("bhsd->bhd", pk)
        num = torch.einsum("bhqd,bhde->bhqe", pq, kv)
        den = torch.einsum("bhqd,bhd->bhq", pq, z)[..., None] + 1e-6
        o = num / den
        return (lambda x, *d: x.permute(*d))(o, 0, 2, 1, 3).reshape(B, S, D) @ wo

    def _B_ref(u, log_A_real, A_imag, C_real, C_imag, log_dt, D_skip):
        L = u.shape[1]
        dt = torch.exp(log_dt)
        A = -torch.exp(log_A_real) + 1j * A_imag
        C = (C_real + 1j * C_imag) * dt[:, None]
        pos = (lambda x, dt: x.to(dt))(torch.arange(L), log_dt.dtype)
        P = torch.exp((A * dt[:, None])[:, :, None] * pos[None, None, :])
        K = 2.0 * torch.einsum("dn,dnl->dl", C, P).real
        L2 = 2 * L
        u_t = (lambda x, *d: x.permute(*d))(u, 0, 2, 1)
        Kf = (lambda x, *a, **k: torch.fft.rfft(x.float(), *a, **k))(K, L2)
        Uf = (lambda x, *a, **k: torch.fft.rfft(x.float(), *a, **k))(u_t, L2)
        y = (lambda x, *a, **k: torch.fft.irfft(x, *a, **k).to(torch.bfloat16))(Uf * Kf[None, :, :], L2)[:, :, :L]
        y = (lambda x, *d: x.permute(*d))(y, 0, 2, 1)
        return y + u * D_skip[None, None, :]

    x = A_x
    g = _sigmoid((x * gate_w).sum(-1, keepdims=True))
    a = _A_ref(x, A_wqkv, A_wo)
    b = _B_ref(x, B_log_A_real, B_A_imag, B_C_real, B_C_imag, B_log_dt, B_D_skip)
    return g * a + (1 - g) * b
```

```asm
; @launch grid=(256,1,1) block=(512,1,1) lds=163840
.amdgcn_target "amdgcn-amd-amdhsa--gfx950"
.text
.globl gated_mix__linear_attn_block__ssm_conv_s4d__prompt_kernel
.p2align 8
.type gated_mix__linear_attn_block__ssm_conv_s4d__prompt_kernel,@function
gated_mix__linear_attn_block__ssm_conv_s4d__prompt_kernel:
    s_load_dwordx16 s[4:19], s[0:1], 0
    s_load_dwordx8 s[20:27], s[0:1], 64
    s_load_dwordx4 s[28:31], s[0:1], 96
    v_lshrrev_b32 v2, 6, v0
    v_and_b32 v1, 63, v0
    s_cmp_ge_u32 s2, 256
    s_cbranch_scc1 K_end
    v_readfirstlane_b32 s51, v2
    s_lshl_b32 s65, s2, 3
    s_mov_b32 s64, s51

    s_cmp_lg_u32 s51, 0
    s_cbranch_scc1 K_nopf
    s_getpc_b64 s[44:45]
K_pc:
    s_and_b32 s3, s2, 0xf8
    v_add_u32 v2, s3, v1
    v_lshlrev_b32 v2, 7, v2
    v_min_u32 v2, K_end-K_pc, v2
    s_mov_b64 exec, 0xff
    global_load_dword v255, v2, s[44:45]
    s_mov_b64 exec, -1
K_nopf:

    s_waitcnt lgkmcnt(0)
    s_add_u32 s65, s65, s51

    s_mov_b32 s32, s4
    s_mov_b32 s33, s5
    s_mov_b32 s34, 2621440
    s_mov_b32 s35, 0x20000
    s_mov_b32 s40, s30
    s_mov_b32 s41, s31
    s_mov_b32 s42, 8388608
    s_mov_b32 s43, 0x20000
    s_cmp_ge_u32 s2, 208
    s_cbranch_scc1 K_help
    s_cmp_ge_u32 s2, 128
    s_cbranch_scc1 K_ssm

    s_and_b32 s3, s2, 7
    s_lshr_b32 s54, s2, 3
    s_and_b32 s50, s3, 3
    s_lshl_b32 s50, s50, 2
    s_and_b32 s55, s54, 3
    s_add_u32 s50, s50, s55
    s_lshr_b32 s52, s3, 2
    s_lshl_b32 s52, s52, 2
    s_lshr_b32 s54, s54, 2
    s_add_u32 s52, s52, s54
    s_add_u32 s53, s54, s55
    s_and_b32 s53, s53, 3
    s_mul_i32 s53, s53, 5
    s_lshr_b32 s53, s53, 1
    s_mov_b32 s60, 0x3fb8aa3b
    s_mov_b32 s61, 0x358637bd
    s_cmp_lt_u32 s51, 4
    s_cbranch_scc1 G_kv

    s_mov_b32 s36, s6
    s_mov_b32 s37, s7
    s_mov_b32 s38, 2457600
    s_mov_b32 s39, 0x20000
    s_sub_u32 s51, s51, 4
    s_lshl_b32 s54, s50, 2
    s_add_u32 s54, s54, s51
    s_mul_i32 s54, s54, 40960
    v_lshrrev_b32 v2, 3, v1
    v_mul_u32_u24 v2, 1280, v2
    v_lshrrev_b32 v3, 4, v1
    v_and_b32 v4, 7, v1
    v_xor_b32 v3, v3, v4
    v_lshl_add_u32 v2, v3, 4, v2
    v_add_u32 v8, s54, v2
    v_xor_b32 v2, 64, v2
    s_add_u32 s54, s54, 10240
    v_add_u32 v9, s54, v2
    v_add_u32 v10, 20480, v8
    v_add_u32 v11, 20480, v9
    s_lshl_b32 s44, s51, 12
    s_lshl_b32 s46, s53, 7

    s_add_u32 m0, s44, 0
    s_nop 0
    buffer_load_dwordx4 v8, s[32:35], s46 offen lds
    s_add_u32 m0, s44, 1024
    s_nop 0
    buffer_load_dwordx4 v9, s[32:35], s46 offen lds
    s_add_u32 m0, s44, 2048
    s_nop 0
    buffer_load_dwordx4 v10, s[32:35], s46 offen lds
    s_add_u32 m0, s44, 3072
    s_nop 0
    buffer_load_dwordx4 v11, s[32:35], s46 offen lds
    s_and_b32 s54, s51, 1
    s_lshr_b32 s55, s51, 1
    s_mul_i32 s56, s54, 122880
    s_mul_i32 s57, s52, 160
    s_add_u32 s56, s56, s57
    s_mul_i32 s45, s54, 5120
    s_mul_i32 s57, s55, 10256
    s_add_u32 s48, s45, s57
    s_add_u32 s48, s48, 16384
    s_mul_i32 s49, s55, 1280
    s_add_u32 s49, s49, 1280
    s_mul_i32 s47, s53, 245760
    s_add_u32 s47, s47, s49

    v_add_u32 v2, 0, v1
    v_mul_u32_u24 v3, 6554, v2
    v_lshrrev_b32 v3, 16, v3
    v_mul_u32_u24 v4, 10, v3
    v_sub_u32 v2, v2, v4
    v_lshrrev_b32 v4, 1, v3
    v_xor_b32 v4, v4, v3
    v_and_b32 v4, 4, v4
    v_mul_u32_u24 v4, 3, v4
    v_xor_b32 v3, v3, v4
    v_mul_u32_u24 v3, 3840, v3
    v_lshl_add_u32 v2, v2, 4, v3
    v_add_u32 v12, s56, v2
    s_add_u32 m0, s48, 0
    s_nop 0
    buffer_load_dwordx4 v12, s[36:39], s47 offen  lds

    v_add_u32 v2, 64, v1
    v_mul_u32_u24 v3, 6554, v2
    v_lshrrev_b32 v3, 16, v3
    v_mul_u32_u24 v4, 10, v3
    v_sub_u32 v2, v2, v4
    v_lshrrev_b32 v4, 1, v3
    v_xor_b32 v4, v4, v3
    v_and_b32 v4, 4, v4
    v_mul_u32_u24 v4, 3, v4
    v_xor_b32 v3, v3, v4
    v_mul_u32_u24 v3, 3840, v3
    v_lshl_add_u32 v2, v2, 4, v3
    v_add_u32 v13, s56, v2
    s_add_u32 m0, s48, 1024
    s_nop 0
    buffer_load_dwordx4 v13, s[36:39], s47 offen  lds

    v_add_u32 v2, 128, v1
    v_mul_u32_u24 v3, 6554, v2
    v_lshrrev_b32 v3, 16, v3
    v_mul_u32_u24 v4, 10, v3
    v_sub_u32 v2, v2, v4
    v_lshrrev_b32 v4, 1, v3
    v_xor_b32 v4, v4, v3
    v_and_b32 v4, 4, v4
    v_mul_u32_u24 v4, 3, v4
    v_xor_b32 v3, v3, v4
    v_mul_u32_u24 v3, 3840, v3
    v_lshl_add_u32 v2, v2, 4, v3
    v_add_u32 v14, s56, v2
    s_add_u32 m0, s48, 2048
    s_nop 0
    buffer_load_dwordx4 v14, s[36:39], s47 offen  lds

    v_add_u32 v2, 192, v1
    v_mul_u32_u24 v3, 6554, v2
    v_lshrrev_b32 v3, 16, v3
    v_mul_u32_u24 v4, 10, v3
    v_sub_u32 v2, v2, v4
    v_lshrrev_b32 v4, 1, v3
    v_xor_b32 v4, v4, v3
    v_and_b32 v4, 4, v4
    v_mul_u32_u24 v4, 3, v4
    v_xor_b32 v3, v3, v4
    v_mul_u32_u24 v3, 3840, v3
    v_lshl_add_u32 v2, v2, 4, v3
    v_add_u32 v15, s56, v2
    s_add_u32 m0, s48, 3072
    s_nop 0
    buffer_load_dwordx4 v15, s[36:39], s47 offen  lds

    v_add_u32 v2, 256, v1
    v_mul_u32_u24 v3, 6554, v2
    v_lshrrev_b32 v3, 16, v3
    v_mul_u32_u24 v4, 10, v3
    v_sub_u32 v2, v2, v4
    v_lshrrev_b32 v4, 1, v3
    v_xor_b32 v4, v4, v3
    v_and_b32 v4, 4, v4
    v_mul_u32_u24 v4, 3, v4
    v_xor_b32 v3, v3, v4
    v_mul_u32_u24 v3, 3840, v3
    v_lshl_add_u32 v2, v2, 4, v3
    v_add_u32 v16, s56, v2
    s_add_u32 m0, s48, 4096
    s_nop 0
    buffer_load_dwordx4 v16, s[36:39], s47 offen  lds

    s_add_u32 s46, s46, 128
    s_add_u32 s47, s47, 245760
    s_cmp_eq_u32 s46, 1280
    s_cselect_b32 s46, 0, s46
    s_cselect_b32 s47, s49, s47
    s_add_u32 m0, s44, 36880
    s_nop 0
    buffer_load_dwordx4 v8, s[32:35], s46 offen lds
    s_add_u32 m0, s44, 37904
    s_nop 0
    buffer_load_dwordx4 v9, s[32:35], s46 offen lds
    s_add_u32 m0, s44, 38928
    s_nop 0
    buffer_load_dwordx4 v10, s[32:35], s46 offen lds
    s_add_u32 m0, s44, 39952
    s_nop 0
    buffer_load_dwordx4 v11, s[32:35], s46 offen lds
    s_add_u32 m0, s48, 36880
    s_nop 0
    buffer_load_dwordx4 v12, s[36:39], s47 offen lds
    s_add_u32 m0, s48, 37904
    s_nop 0
    buffer_load_dwordx4 v13, s[36:39], s47 offen lds
    s_add_u32 m0, s48, 38928
    s_nop 0
    buffer_load_dwordx4 v14, s[36:39], s47 offen lds
    s_add_u32 m0, s48, 39952
    s_nop 0
    buffer_load_dwordx4 v15, s[36:39], s47 offen lds
    s_add_u32 m0, s48, 40976
    s_nop 0
    buffer_load_dwordx4 v16, s[36:39], s47 offen lds
    v_and_b32 v5, 15, v1
    v_lshrrev_b32 v6, 4, v1
    v_and_b32 v7, 3, v1
    v_lshrrev_b32 v2, 1, v5
    v_xor_b32 v2, v2, v6
    v_lshlrev_b32 v2, 4, v2
    v_lshl_add_u32 v2, v5, 7, v2
    v_bfe_u32 v3, v1, 2, 3
    v_lshrrev_b32 v4, 5, v1
    v_lshl_add_u32 v3, v4, 4, v3
    v_mul_u32_u24 v3, 160, v3

    v_add_u32 v2, s44, v2
    v_xor_b32 v4, 64, v2
    v_add_u32 v18, 73760, v2
    v_add_u32 v19, 73760, v4
    v_mul_u32_u24 v17, 40, v7
    v_add3_u32 v17, v17, v3, 32
    v_lshl_add_u32 v3, v7, 3, v3

    s_waitcnt vmcnt(9)
    s_waitcnt lgkmcnt(0)
    s_barrier
    s_add_u32 s46, s46, 128
    s_add_u32 s47, s47, 245760
    s_cmp_eq_u32 s46, 1280
    s_cselect_b32 s46, 0, s46
    s_cselect_b32 s47, s49, s47
    s_add_u32 m0, s44, 73760
    s_nop 0
    buffer_load_dwordx4 v8, s[32:35], s46 offen lds
    s_add_u32 m0, s44, 74784
    s_nop 0
    buffer_load_dwordx4 v9, s[32:35], s46 offen lds
    s_add_u32 m0, s44, 75808
    s_nop 0
    buffer_load_dwordx4 v10, s[32:35], s46 offen lds
    ds_read_b128 v[20:23], v2 offset:0
    ds_read_b128 v[24:27], v2 offset:2048
    ds_read_b128 v[28:31], v4 offset:0
    ds_read_b128 v[32:35], v4 offset:2048
    s_add_u32 m0, s44, 76832
    s_nop 0
    buffer_load_dwordx4 v11, s[32:35], s46 offen lds
    s_add_u32 m0, s48, 73760
    s_nop 0
    buffer_load_dwordx4 v12, s[36:39], s47 offen lds
    s_add_u32 m0, s48, 74784
    s_nop 0
    buffer_load_dwordx4 v13, s[36:39], s47 offen lds
    s_add_u32 m0, s48, 75808
    s_nop 0
    buffer_load_dwordx4 v14, s[36:39], s47 offen lds
    s_add_u32 m0, s48, 76832
    s_nop 0
    buffer_load_dwordx4 v15, s[36:39], s47 offen lds
    s_add_u32 m0, s48, 77856
    s_nop 0
    buffer_load_dwordx4 v16, s[36:39], s47 offen lds
    s_waitcnt vmcnt(9)
    s_waitcnt lgkmcnt(0)
    s_barrier
    s_add_u32 s46, s46, 128
    s_add_u32 s47, s47, 245760
    s_cmp_eq_u32 s46, 1280
    s_cselect_b32 s46, 0, s46
    s_cselect_b32 s47, s49, s47
    s_add_u32 m0, s44, 0
    s_nop 0
    buffer_load_dwordx4 v8, s[32:35], s46 offen lds
    s_add_u32 m0, s44, 1024
    s_nop 0
    buffer_load_dwordx4 v9, s[32:35], s46 offen lds
    s_add_u32 m0, s44, 2048
    s_nop 0
    buffer_load_dwordx4 v10, s[32:35], s46 offen lds
    ds_read_b128 v[36:39], v2 offset:36880
    ds_read_b128 v[40:43], v2 offset:38928
    ds_read_b128 v[44:47], v4 offset:36880
    ds_read_b128 v[48:51], v4 offset:38928
    s_add_u32 m0, s44, 3072
    s_nop 0
    buffer_load_dwordx4 v11, s[32:35], s46 offen lds
    s_and_b32 s62, s2, 7
    s_lshl_b32 s62, s62, 2
    s_lshr_b32 s63, s2, 6
    s_add_u32 s62, s62, s63
    s_bfe_u32 s63, s2, 0x30003
    v_and_b32 v255, 255, v0
    s_lshl_b32 s59, s51, 10
    s_add_u32 m0, s48, 0
    s_nop 0
    buffer_load_dwordx4 v12, s[36:39], s47 offen lds
    s_add_u32 m0, s48, 1024
    s_nop 0
    buffer_load_dwordx4 v13, s[36:39], s47 offen lds
    s_add_u32 m0, s48, 2048
    s_nop 0
    buffer_load_dwordx4 v14, s[36:39], s47 offen lds
    s_add_u32 m0, s48, 3072
    s_nop 0
    buffer_load_dwordx4 v15, s[36:39], s47 offen lds
    s_add_u32 m0, s48, 4096
    s_nop 0
    buffer_load_dwordx4 v16, s[36:39], s47 offen lds
    s_waitcnt vmcnt(9)
    s_waitcnt lgkmcnt(0)
    s_barrier
    s_add_u32 s46, s46, 128
    s_add_u32 s47, s47, 245760
    s_cmp_eq_u32 s46, 1280
    s_cselect_b32 s46, 0, s46
    s_cselect_b32 s47, s49, s47
    s_add_u32 m0, s44, 36880
    s_nop 0
    buffer_load_dwordx4 v8, s[32:35], s46 offen lds
    s_add_u32 m0, s44, 37904
    s_nop 0
    buffer_load_dwordx4 v9, s[32:35], s46 offen lds
    s_add_u32 m0, s44, 38928
    s_nop 0
    buffer_load_dwordx4 v10, s[32:35], s46 offen lds
    ds_read_b128 v[52:55], v18 offset:0
    ds_read_b128 v[56:59], v18 offset:2048
    ds_read_b128 v[60:63], v19 offset:0
    ds_read_b128 v[64:67], v19 offset:2048
    s_add_u32 m0, s44, 39952
    s_nop 0
    buffer_load_dwordx4 v11, s[32:35], s46 offen lds
    s_mov_b32 s92, s8
    s_mov_b32 s93, s9
    s_mov_b32 s94, 819200
    s_mov_b32 s95, 0x20000
    s_mul_i32 s3, s63, 160
    v_add_u32 v248, 0, v255
    v_mul_u32_u24 v249, 6554, v248
    s_add_u32 m0, s48, 36880
    s_nop 0
    buffer_load_dwordx4 v12, s[36:39], s47 offen lds
    s_add_u32 m0, s48, 37904
    s_nop 0
    buffer_load_dwordx4 v13, s[36:39], s47 offen lds
    s_add_u32 m0, s48, 38928
    s_nop 0
    buffer_load_dwordx4 v14, s[36:39], s47 offen lds
    s_add_u32 m0, s48, 39952
    s_nop 0
    buffer_load_dwordx4 v15, s[36:39], s47 offen lds
    s_add_u32 m0, s48, 40976
    s_nop 0
    buffer_load_dwordx4 v16, s[36:39], s47 offen lds
    s_waitcnt vmcnt(9)
    s_waitcnt lgkmcnt(0)
    s_barrier
    s_add_u32 s46, s46, 128
    s_add_u32 s47, s47, 245760
    s_cmp_eq_u32 s46, 1280
    s_cselect_b32 s46, 0, s46
    s_cselect_b32 s47, s49, s47
    s_add_u32 m0, s44, 73760
    s_nop 0
    buffer_load_dwordx4 v8, s[32:35], s46 offen lds
    s_add_u32 m0, s44, 74784
    s_nop 0
    buffer_load_dwordx4 v9, s[32:35], s46 offen lds
    s_add_u32 m0, s44, 75808
    s_nop 0
    buffer_load_dwordx4 v10, s[32:35], s46 offen lds
    ds_read_b128 v[68:71], v2 offset:0
    ds_read_b128 v[72:75], v2 offset:2048
    ds_read_b128 v[76:79], v4 offset:0
    ds_read_b128 v[80:83], v4 offset:2048
    s_add_u32 m0, s44, 76832
    s_nop 0
    buffer_load_dwordx4 v11, s[32:35], s46 offen lds
    v_lshrrev_b32 v249, 16, v249
    v_mul_u32_u24 v249, 1120, v249
    v_lshl_add_u32 v248, v248, 4, v249
    v_add_u32 v250, s3, v248
    v_add_u32 v248, 256, v255
    v_mul_u32_u24 v249, 6554, v248
    v_lshrrev_b32 v249, 16, v249
    s_add_u32 m0, s48, 73760
    s_nop 0
    buffer_load_dwordx4 v12, s[36:39], s47 offen lds
    s_add_u32 m0, s48, 74784
    s_nop 0
    buffer_load_dwordx4 v13, s[36:39], s47 offen lds
    s_add_u32 m0, s48, 75808
    s_nop 0
    buffer_load_dwordx4 v14, s[36:39], s47 offen lds
    s_add_u32 m0, s48, 76832
    s_nop 0
    buffer_load_dwordx4 v15, s[36:39], s47 offen lds
    s_add_u32 m0, s48, 77856
    s_nop 0
    buffer_load_dwordx4 v16, s[36:39], s47 offen lds
    s_waitcnt vmcnt(9)
    s_waitcnt lgkmcnt(0)
    s_barrier
    s_add_u32 s46, s46, 128
    s_add_u32 s47, s47, 245760
    s_cmp_eq_u32 s46, 1280
    s_cselect_b32 s46, 0, s46
    s_cselect_b32 s47, s49, s47
    s_add_u32 m0, s44, 0
    s_nop 0
    buffer_load_dwordx4 v8, s[32:35], s46 offen lds
    s_add_u32 m0, s44, 1024
    s_nop 0
    buffer_load_dwordx4 v9, s[32:35], s46 offen lds
    s_add_u32 m0, s44, 2048
    s_nop 0
    buffer_load_dwordx4 v10, s[32:35], s46 offen lds
    ds_read_b128 v[84:87], v2 offset:36880
    ds_read_b128 v[88:91], v2 offset:38928
    ds_read_b128 v[92:95], v4 offset:36880
    ds_read_b128 v[96:99], v4 offset:38928
    s_add_u32 m0, s44, 3072
    s_nop 0
    buffer_load_dwordx4 v11, s[32:35], s46 offen lds
    v_mul_u32_u24 v249, 1120, v249
    v_lshl_add_u32 v248, v248, 4, v249
    v_add_u32 v251, s3, v248
    v_add_u32 v248, 512, v255
    v_mul_u32_u24 v249, 6554, v248
    v_lshrrev_b32 v249, 16, v249
    v_mul_u32_u24 v249, 1120, v249
    s_add_u32 m0, s48, 0
    s_nop 0
    buffer_load_dwordx4 v12, s[36:39], s47 offen lds
    s_add_u32 m0, s48, 1024
    s_nop 0
    buffer_load_dwordx4 v13, s[36:39], s47 offen lds
    s_add_u32 m0, s48, 2048
    s_nop 0
    buffer_load_dwordx4 v14, s[36:39], s47 offen lds
    s_add_u32 m0, s48, 3072
    s_nop 0
    buffer_load_dwordx4 v15, s[36:39], s47 offen lds
    s_add_u32 m0, s48, 4096
    s_nop 0
    buffer_load_dwordx4 v16, s[36:39], s47 offen lds
    s_waitcnt vmcnt(9)
    s_waitcnt lgkmcnt(0)
    s_barrier
    s_add_u32 s46, s46, 128
    s_add_u32 s47, s47, 245760
    s_cmp_eq_u32 s46, 1280
    s_cselect_b32 s46, 0, s46
    s_cselect_b32 s47, s49, s47
    s_add_u32 m0, s44, 36880
    s_nop 0
    buffer_load_dwordx4 v8, s[32:35], s46 offen lds
    s_add_u32 m0, s44, 37904
    s_nop 0
    buffer_load_dwordx4 v9, s[32:35], s46 offen lds
    s_add_u32 m0, s44, 38928
    s_nop 0
    buffer_load_dwordx4 v10, s[32:35], s46 offen lds
    ds_read_b128 v[100:103], v18 offset:0
    ds_read_b128 v[104:107], v18 offset:2048
    ds_read_b128 v[108:111], v19 offset:0
    ds_read_b128 v[112:115], v19 offset:2048
    s_add_u32 m0, s44, 39952
    s_nop 0
    buffer_load_dwordx4 v11, s[32:35], s46 offen lds
    v_lshl_add_u32 v248, v248, 4, v249
    v_add_u32 v252, s3, v248
    v_add_u32 v248, 768, v255
    v_mul_u32_u24 v249, 6554, v248
    v_lshrrev_b32 v249, 16, v249
    v_mul_u32_u24 v249, 1120, v249
    v_lshl_add_u32 v248, v248, 4, v249
    s_add_u32 m0, s48, 36880
    s_nop 0
    buffer_load_dwordx4 v12, s[36:39], s47 offen lds
    s_add_u32 m0, s48, 37904
    s_nop 0
    buffer_load_dwordx4 v13, s[36:39], s47 offen lds
    s_add_u32 m0, s48, 38928
    s_nop 0
    buffer_load_dwordx4 v14, s[36:39], s47 offen lds
    s_add_u32 m0, s48, 39952
    s_nop 0
    buffer_load_dwordx4 v15, s[36:39], s47 offen lds
    s_add_u32 m0, s48, 40976
    s_nop 0
    buffer_load_dwordx4 v16, s[36:39], s47 offen lds
    s_waitcnt vmcnt(9)
    s_waitcnt lgkmcnt(0)
    s_barrier
    s_add_u32 s46, s46, 128
    s_add_u32 s47, s47, 245760
    s_cmp_eq_u32 s46, 1280
    s_cselect_b32 s46, 0, s46
    s_cselect_b32 s47, s49, s47
    s_add_u32 m0, s44, 73760
    s_nop 0
    buffer_load_dwordx4 v8, s[32:35], s46 offen lds
    s_add_u32 m0, s44, 74784
    s_nop 0
    buffer_load_dwordx4 v9, s[32:35], s46 offen lds
    s_add_u32 m0, s44, 75808
    s_nop 0
    buffer_load_dwordx4 v10, s[32:35], s46 offen lds
    ds_read_b128 v[116:119], v2 offset:0
    ds_read_b128 v[120:123], v2 offset:2048
    ds_read_b128 v[124:127], v4 offset:0
    ds_read_b128 v[128:131], v4 offset:2048
    s_add_u32 m0, s44, 76832
    s_nop 0
    buffer_load_dwordx4 v11, s[32:35], s46 offen lds
    v_add_u32 v253, s3, v248
    v_add_u32 v248, 1024, v255
    v_mul_u32_u24 v249, 6554, v248
    v_lshrrev_b32 v249, 16, v249
    v_mul_u32_u24 v249, 1120, v249
    v_lshl_add_u32 v248, v248, 4, v249
    v_add_u32 v254, s3, v248
    s_add_u32 m0, s48, 73760
    s_nop 0
    buffer_load_dwordx4 v12, s[36:39], s47 offen lds
    s_add_u32 m0, s48, 74784
    s_nop 0
    buffer_load_dwordx4 v13, s[36:39], s47 offen lds
    s_add_u32 m0, s48, 75808
    s_nop 0
    buffer_load_dwordx4 v14, s[36:39], s47 offen lds
    s_add_u32 m0, s48, 76832
    s_nop 0
    buffer_load_dwordx4 v15, s[36:39], s47 offen lds
    s_add_u32 m0, s48, 77856
    s_nop 0
    buffer_load_dwordx4 v16, s[36:39], s47 offen lds
    s_waitcnt vmcnt(9)
    s_waitcnt lgkmcnt(0)
    s_barrier
    s_add_u32 s46, s46, 128
    s_add_u32 s47, s47, 245760
    s_cmp_eq_u32 s46, 1280
    s_cselect_b32 s46, 0, s46
    s_cselect_b32 s47, s49, s47
    s_add_u32 m0, s44, 0
    s_nop 0
    buffer_load_dwordx4 v8, s[32:35], s46 offen lds
    s_add_u32 m0, s44, 1024
    s_nop 0
    buffer_load_dwordx4 v9, s[32:35], s46 offen lds
    s_add_u32 m0, s44, 2048
    s_nop 0
    buffer_load_dwordx4 v10, s[32:35], s46 offen lds
    ds_read_b128 v[132:135], v2 offset:36880
    ds_read_b128 v[136:139], v2 offset:38928
    ds_read_b128 v[140:143], v4 offset:36880
    ds_read_b128 v[144:147], v4 offset:38928
    s_add_u32 m0, s44, 3072
    s_nop 0
    buffer_load_dwordx4 v11, s[32:35], s46 offen lds
    s_add_u32 m0, s48, 0
    s_nop 0
    buffer_load_dwordx4 v12, s[36:39], s47 offen lds
    s_add_u32 m0, s48, 1024
    s_nop 0
    buffer_load_dwordx4 v13, s[36:39], s47 offen lds
    s_add_u32 m0, s48, 2048
    s_nop 0
    buffer_load_dwordx4 v14, s[36:39], s47 offen lds
    s_add_u32 m0, s48, 3072
    s_nop 0
    buffer_load_dwordx4 v15, s[36:39], s47 offen lds
    s_add_u32 m0, s48, 4096
    s_nop 0
    buffer_load_dwordx4 v16, s[36:39], s47 offen lds
    s_add_u32 s57, s53, s55
    s_add_u32 s57, s57, 0
    s_cmp_ge_u32 s57, 10
    s_cselect_b32 s58, 10, 0
    s_sub_u32 s57, s57, s58
    s_mul_i32 s57, s57, 245760
    s_cmp_eq_u32 s55, 0
    s_mov_b32 s58, 120880
    s_cselect_b32 s58, 110640, s58
    s_add_u32 s58, s58, s45
    s_add_u32 m0, s58, 0
    s_nop 0
    buffer_load_dwordx4 v12, s[36:39], s57 offen lds
    s_waitcnt vmcnt(10)
    s_waitcnt lgkmcnt(0)
    s_barrier
    s_add_u32 m0, s58, 1024
    s_nop 0
    buffer_load_dwordx4 v13, s[36:39], s57 offen lds
    s_add_u32 m0, s58, 2048
    s_nop 0
    buffer_load_dwordx4 v14, s[36:39], s57 offen lds
    s_add_u32 m0, s58, 3072
    s_nop 0
    buffer_load_dwordx4 v15, s[36:39], s57 offen lds
    ds_read_b128 v[148:151], v18 offset:0
    ds_read_b128 v[152:155], v18 offset:2048
    ds_read_b128 v[156:159], v19 offset:0
    ds_read_b128 v[160:163], v19 offset:2048
    s_add_u32 m0, s58, 4096
    s_nop 0
    buffer_load_dwordx4 v16, s[36:39], s57 offen lds
    s_add_u32 s57, s53, s55
    s_add_u32 s57, s57, 2
    s_cmp_ge_u32 s57, 10
    s_cselect_b32 s58, 10, 0
    s_sub_u32 s57, s57, s58
    s_mul_i32 s57, s57, 245760
    s_cmp_eq_u32 s55, 0
    s_mov_b32 s58, 141360
    s_cselect_b32 s58, 131120, s58
    s_add_u32 s58, s58, s45
    s_add_u32 m0, s58, 0
    s_nop 0
    buffer_load_dwordx4 v12, s[36:39], s57 offen lds
    s_add_u32 m0, s58, 1024
    s_nop 0
    buffer_load_dwordx4 v13, s[36:39], s57 offen lds
    s_add_u32 m0, s58, 2048
    s_nop 0
    buffer_load_dwordx4 v14, s[36:39], s57 offen lds
    s_waitcnt vmcnt(8)
    s_waitcnt lgkmcnt(0)
    s_barrier
    s_add_u32 m0, s58, 3072
    s_nop 0
    buffer_load_dwordx4 v15, s[36:39], s57 offen lds
    s_add_u32 m0, s58, 4096
    s_nop 0
    buffer_load_dwordx4 v16, s[36:39], s57 offen lds
    s_add_u32 s57, s53, s55
    s_add_u32 s57, s57, 4
    s_cmp_ge_u32 s57, 10
    s_cselect_b32 s58, 10, 0
    s_sub_u32 s57, s57, s58
    s_mul_i32 s57, s57, 245760
    s_cmp_eq_u32 s55, 0
    s_mov_b32 s58, 59440
    s_cselect_b32 s58, 151600, s58
    s_add_u32 s58, s58, s45
    s_add_u32 m0, s58, 0
    s_nop 0
    buffer_load_dwordx4 v12, s[36:39], s57 offen lds
    ds_read_b128 v[164:167], v2 offset:0
    ds_read_b128 v[168:171], v2 offset:2048
    ds_read_b128 v[172:175], v4 offset:0
    ds_read_b128 v[176:179], v4 offset:2048
    s_add_u32 m0, s58, 1024
    s_nop 0
    buffer_load_dwordx4 v13, s[36:39], s57 offen lds
    s_add_u32 m0, s58, 2048
    s_nop 0
    buffer_load_dwordx4 v14, s[36:39], s57 offen lds
    s_add_u32 m0, s58, 3072
    s_nop 0
    buffer_load_dwordx4 v15, s[36:39], s57 offen lds
    s_add_u32 m0, s58, 4096
    s_nop 0
    buffer_load_dwordx4 v16, s[36:39], s57 offen lds
    s_add_u32 s57, s53, s55
    s_add_u32 s57, s57, 6
    s_cmp_ge_u32 s57, 10
    s_cselect_b32 s58, 10, 0
    s_sub_u32 s57, s57, s58
    s_mul_i32 s57, s57, 245760
    s_cmp_eq_u32 s55, 0
    s_mov_b32 s58, 79920
    s_cselect_b32 s58, 69680, s58
    s_add_u32 s58, s58, s45
    s_add_u32 m0, s58, 0
    s_nop 0
    buffer_load_dwordx4 v12, s[36:39], s57 offen lds
    v_add_u32 v18, 110640, v3
    v_add_u32 v19, 110640, v17
    v_add_u32 v3, 59440, v3
    v_add_u32 v17, 59440, v17
    s_waitcnt vmcnt(11)
    s_waitcnt lgkmcnt(0)
    s_barrier
    ds_read_b64_tr_b16 v[220:221], v18 offset:0
    ds_read_b64_tr_b16 v[222:223], v18 offset:1280
    ds_read_b64_tr_b16 v[224:225], v18 offset:40
    ds_read_b64_tr_b16 v[226:227], v18 offset:1320
    ds_read_b64_tr_b16 v[228:229], v18 offset:80
    ds_read_b64_tr_b16 v[230:231], v18 offset:1360
    ds_read_b64_tr_b16 v[232:233], v18 offset:120
    ds_read_b64_tr_b16 v[234:235], v18 offset:1400
    ds_read_b64_tr_b16 v[236:237], v19 offset:0
    ds_read_b64_tr_b16 v[238:239], v19 offset:1280
    ds_read_b64_tr_b16 v[240:241], v18 offset:5120
    ds_read_b64_tr_b16 v[242:243], v18 offset:6400
    s_waitcnt lgkmcnt(10)
    v_mfma_f32_16x16x32_bf16 v[180:183], v[220:223], v[20:23], 0
    v_mfma_f32_16x16x32_bf16 v[200:203], v[220:223], v[24:27], 0
    s_add_u32 m0, s58, 1024
    s_nop 0
    buffer_load_dwordx4 v13, s[36:39], s57 offen lds
    ds_read_b64_tr_b16 v[244:245], v18 offset:5160
    ds_read_b64_tr_b16 v[246:247], v18 offset:6440
    s_waitcnt lgkmcnt(10)
    v_mfma_f32_16x16x32_bf16 v[184:187], v[224:227], v[20:23], 0
    v_mfma_f32_16x16x32_bf16 v[204:207], v[224:227], v[24:27], 0
    s_add_u32 m0, s58, 2048
    s_nop 0
    buffer_load_dwordx4 v14, s[36:39], s57 offen lds
    ds_read_b64_tr_b16 v[220:221], v18 offset:5200
    ds_read_b64_tr_b16 v[222:223], v18 offset:6480
    s_waitcnt lgkmcnt(10)
    v_mfma_f32_16x16x32_bf16 v[188:191], v[228:231], v[20:23], 0
    v_mfma_f32_16x16x32_bf16 v[208:211], v[228:231], v[24:27], 0
    ds_read_b64_tr_b16 v[224:225], v18 offset:5240
    ds_read_b64_tr_b16 v[226:227], v18 offset:6520
    s_waitcnt lgkmcnt(10)
    v_mfma_f32_16x16x32_bf16 v[192:195], v[232:235], v[20:23], 0
    v_mfma_f32_16x16x32_bf16 v[212:215], v[232:235], v[24:27], 0
    s_add_u32 m0, s58, 3072
    s_nop 0
    buffer_load_dwordx4 v15, s[36:39], s57 offen lds
    ds_read_b64_tr_b16 v[228:229], v19 offset:5120
    ds_read_b64_tr_b16 v[230:231], v19 offset:6400
    s_waitcnt lgkmcnt(10)
    v_mfma_f32_16x16x32_bf16 v[196:199], v[236:239], v[20:23], 0
    v_mfma_f32_16x16x32_bf16 v[216:219], v[236:239], v[24:27], 0
    ds_read_b64_tr_b16 v[232:233], v18 offset:10240
    ds_read_b64_tr_b16 v[234:235], v18 offset:11520
    s_waitcnt lgkmcnt(10)
    v_mfma_f32_16x16x32_bf16 v[180:183], v[240:243], v[28:31], v[180:183]
    v_mfma_f32_16x16x32_bf16 v[200:203], v[240:243], v[32:35], v[200:203]
    s_add_u32 m0, s58, 4096
    s_nop 0
    buffer_load_dwordx4 v16, s[36:39], s57 offen lds
    ds_read_b64_tr_b16 v[236:237], v18 offset:10280
    ds_read_b64_tr_b16 v[238:239], v18 offset:11560
    s_waitcnt lgkmcnt(10)
    v_mfma_f32_16x16x32_bf16 v[184:187], v[244:247], v[28:31], v[184:187]
    v_mfma_f32_16x16x32_bf16 v[204:207], v[244:247], v[32:35], v[204:207]
    s_add_u32 s57, s53, s55
    s_add_u32 s57, s57, 8
    s_cmp_ge_u32 s57, 10
    s_cselect_b32 s58, 10, 0
    s_sub_u32 s57, s57, s58
    s_mul_i32 s57, s57, 245760
    s_cmp_eq_u32 s55, 0
    s_mov_b32 s58, 100400
    s_cselect_b32 s58, 90160, s58
    s_add_u32 s58, s58, s45
    s_add_u32 m0, s58, 0
    s_nop 0
    buffer_load_dwordx4 v12, s[36:39], s57 offen lds
    ds_read_b64_tr_b16 v[240:241], v18 offset:10320
    ds_read_b64_tr_b16 v[242:243], v18 offset:11600
    s_waitcnt lgkmcnt(10)
    v_mfma_f32_16x16x32_bf16 v[188:191], v[220:223], v[28:31], v[188:191]
    v_mfma_f32_16x16x32_bf16 v[208:211], v[220:223], v[32:35], v[208:211]
    ds_read_b64_tr_b16 v[244:245], v18 offset:10360
    ds_read_b64_tr_b16 v[246:247], v18 offset:11640
    s_waitcnt lgkmcnt(10)
    v_mfma_f32_16x16x32_bf16 v[192:195], v[224:227], v[28:31], v[192:195]
    v_mfma_f32_16x16x32_bf16 v[212:215], v[224:227], v[32:35], v[212:215]
    s_add_u32 m0, s58, 1024
    s_nop 0
    buffer_load_dwordx4 v13, s[36:39], s57 offen lds
    ds_read_b64_tr_b16 v[220:221], v19 offset:10240
    ds_read_b64_tr_b16 v[222:223], v19 offset:11520
    s_waitcnt lgkmcnt(10)
    v_mfma_f32_16x16x32_bf16 v[196:199], v[228:231], v[28:31], v[196:199]
    v_mfma_f32_16x16x32_bf16 v[216:219], v[228:231], v[32:35], v[216:219]
    ds_read_b64_tr_b16 v[224:225], v18 offset:15360
    ds_read_b64_tr_b16 v[226:227], v18 offset:16640
    s_waitcnt lgkmcnt(10)
    v_mfma_f32_16x16x32_bf16 v[180:183], v[232:235], v[36:39], v[180:183]
    v_mfma_f32_16x16x32_bf16 v[200:203], v[232:235], v[40:43], v[200:203]
    s_add_u32 m0, s58, 2048
    s_nop 0
    buffer_load_dwordx4 v14, s[36:39], s57 offen lds
    ds_read_b64_tr_b16 v[228:229], v18 offset:15400
    ds_read_b64_tr_b16 v[230:231], v18 offset:16680
    s_waitcnt lgkmcnt(10)
    v_mfma_f32_16x16x32_bf16 v[184:187], v[236:239], v[36:39], v[184:187]
    v_mfma_f32_16x16x32_bf16 v[204:207], v[236:239], v[40:43], v[204:207]
    s_add_u32 m0, s58, 3072
    s_nop 0
    buffer_load_dwordx4 v15, s[36:39], s57 offen lds
    ds_read_b64_tr_b16 v[232:233], v18 offset:15440
    ds_read_b64_tr_b16 v[234:235], v18 offset:16720
    s_waitcnt lgkmcnt(10)
    v_mfma_f32_16x16x32_bf16 v[188:191], v[240:243], v[36:39], v[188:191]
    v_mfma_f32_16x16x32_bf16 v[208:211], v[240:243], v[40:43], v[208:211]
    ds_read_b64_tr_b16 v[236:237], v18 offset:15480
    ds_read_b64_tr_b16 v[238:239], v18 offset:16760
    s_waitcnt lgkmcnt(10)
    v_mfma_f32_16x16x32_bf16 v[192:195], v[244:247], v[36:39], v[192:195]
    v_mfma_f32_16x16x32_bf16 v[212:215], v[244:247], v[40:43], v[212:215]
    s_add_u32 m0, s58, 4096
    s_nop 0
    buffer_load_dwordx4 v16, s[36:39], s57 offen lds
    ds_read_b64_tr_b16 v[240:241], v19 offset:15360
    ds_read_b64_tr_b16 v[242:243], v19 offset:16640
    s_waitcnt lgkmcnt(10)
    v_mfma_f32_16x16x32_bf16 v[196:199], v[220:223], v[36:39], v[196:199]
    v_mfma_f32_16x16x32_bf16 v[216:219], v[220:223], v[40:43], v[216:219]
    s_waitcnt vmcnt(15)
    s_barrier
    ds_read_b64_tr_b16 v[244:245], v18 offset:20480
    ds_read_b64_tr_b16 v[246:247], v18 offset:21760
    s_waitcnt lgkmcnt(10)
    v_mfma_f32_16x16x32_bf16 v[180:183], v[224:227], v[44:47], v[180:183]
    v_mfma_f32_16x16x32_bf16 v[200:203], v[224:227], v[48:51], v[200:203]
    v_mov_b32 v248, 0
    global_load_dword v249, v248, s[28:29] offset:128 sc1
    ds_read_b64_tr_b16 v[220:221], v18 offset:20520
    ds_read_b64_tr_b16 v[222:223], v18 offset:21800
    s_waitcnt lgkmcnt(10)
    v_mfma_f32_16x16x32_bf16 v[184:187], v[228:231], v[44:47], v[184:187]
    v_mfma_f32_16x16x32_bf16 v[204:207], v[228:231], v[48:51], v[204:207]
    s_add_u32 m0, s59, 0
    s_mov_b32 s98, 0
    buffer_load_dwordx4 v250, s[92:95], s98 offen lds
    ds_read_b64_tr_b16 v[224:225], v18 offset:20560
    ds_read_b64_tr_b16 v[226:227], v18 offset:21840
    s_waitcnt lgkmcnt(10)
    v_mfma_f32_16x16x32_bf16 v[188:191], v[232:235], v[44:47], v[188:191]
    v_mfma_f32_16x16x32_bf16 v[208:211], v[232:235], v[48:51], v[208:211]
    ds_read_b64_tr_b16 v[228:229], v18 offset:20600
    ds_read_b64_tr_b16 v[230:231], v18 offset:21880
    s_waitcnt lgkmcnt(10)
    v_mfma_f32_16x16x32_bf16 v[192:195], v[236:239], v[44:47], v[192:195]
    v_mfma_f32_16x16x32_bf16 v[212:215], v[236:239], v[48:51], v[212:215]
    s_add_u32 m0, s59, 4096
    s_mov_b32 s98, 0
    buffer_load_dwordx4 v251, s[92:95], s98 offen lds
    ds_read_b64_tr_b16 v[232:233], v19 offset:20480
    ds_read_b64_tr_b16 v[234:235], v19 offset:21760
    s_waitcnt lgkmcnt(10)
    v_mfma_f32_16x16x32_bf16 v[196:199], v[240:243], v[44:47], v[196:199]
    v_mfma_f32_16x16x32_bf16 v[216:219], v[240:243], v[48:51], v[216:219]
    ds_read_b64_tr_b16 v[236:237], v18 offset:25600
    ds_read_b64_tr_b16 v[238:239], v18 offset:26880
    s_waitcnt lgkmcnt(10)
    v_mfma_f32_16x16x32_bf16 v[180:183], v[244:247], v[52:55], v[180:183]
    v_mfma_f32_16x16x32_bf16 v[200:203], v[244:247], v[56:59], v[200:203]
    s_add_u32 m0, s59, 8192
    s_mov_b32 s98, 0
    buffer_load_dwordx4 v252, s[92:95], s98 offen lds
    ds_read_b64_tr_b16 v[240:241], v18 offset:25640
    ds_read_b64_tr_b16 v[242:243], v18 offset:26920
    s_waitcnt lgkmcnt(10)
    v_mfma_f32_16x16x32_bf16 v[184:187], v[220:223], v[52:55], v[184:187]
    v_mfma_f32_16x16x32_bf16 v[204:207], v[220:223], v[56:59], v[204:207]
    s_add_u32 m0, s59, 12288
    s_mov_b32 s98, 0
    buffer_load_dwordx4 v253, s[92:95], s98 offen lds
    ds_read_b64_tr_b16 v[244:245], v18 offset:25680
    ds_read_b64_tr_b16 v[246:247], v18 offset:26960
    s_waitcnt lgkmcnt(10)
    v_mfma_f32_16x16x32_bf16 v[188:191], v[224:227], v[52:55], v[188:191]
    v_mfma_f32_16x16x32_bf16 v[208:211], v[224:227], v[56:59], v[208:211]
    ds_read_b64_tr_b16 v[220:221], v18 offset:25720
    ds_read_b64_tr_b16 v[222:223], v18 offset:27000
    s_waitcnt lgkmcnt(10)
    v_mfma_f32_16x16x32_bf16 v[192:195], v[228:231], v[52:55], v[192:195]
    v_mfma_f32_16x16x32_bf16 v[212:215], v[228:231], v[56:59], v[212:215]
    s_add_u32 m0, s59, 16384
    s_mov_b32 s98, 0
    buffer_load_dwordx4 v254, s[92:95], s98 offen lds
    ds_read_b64_tr_b16 v[224:225], v19 offset:25600
    ds_read_b64_tr_b16 v[226:227], v19 offset:26880
    s_waitcnt lgkmcnt(10)
    v_mfma_f32_16x16x32_bf16 v[196:199], v[232:235], v[52:55], v[196:199]
    v_mfma_f32_16x16x32_bf16 v[216:219], v[232:235], v[56:59], v[216:219]
    ds_read_b64_tr_b16 v[228:229], v18 offset:30720
    ds_read_b64_tr_b16 v[230:231], v18 offset:32000
    s_waitcnt lgkmcnt(10)
    v_mfma_f32_16x16x32_bf16 v[180:183], v[236:239], v[60:63], v[180:183]
    v_mfma_f32_16x16x32_bf16 v[200:203], v[236:239], v[64:67], v[200:203]
    s_add_u32 m0, s59, 20480
    s_mov_b32 s98, 163840
    buffer_load_dwordx4 v250, s[92:95], s98 offen lds
    ds_read_b64_tr_b16 v[232:233], v18 offset:30760
    ds_read_b64_tr_b16 v[234:235], v18 offset:32040
    s_waitcnt lgkmcnt(10)
    v_mfma_f32_16x16x32_bf16 v[184:187], v[240:243], v[60:63], v[184:187]
    v_mfma_f32_16x16x32_bf16 v[204:207], v[240:243], v[64:67], v[204:207]
    s_add_u32 m0, s59, 24576
    s_mov_b32 s98, 163840
    buffer_load_dwordx4 v251, s[92:95], s98 offen lds
    ds_read_b64_tr_b16 v[236:237], v18 offset:30800
    ds_read_b64_tr_b16 v[238:239], v18 offset:32080
    s_waitcnt lgkmcnt(10)
    v_mfma_f32_16x16x32_bf16 v[188:191], v[244:247], v[60:63], v[188:191]
    v_mfma_f32_16x16x32_bf16 v[208:211], v[244:247], v[64:67], v[208:211]
    ds_read_b64_tr_b16 v[240:241], v18 offset:30840
    ds_read_b64_tr_b16 v[242:243], v18 offset:32120
    s_waitcnt lgkmcnt(10)
    v_mfma_f32_16x16x32_bf16 v[192:195], v[220:223], v[60:63], v[192:195]
    v_mfma_f32_16x16x32_bf16 v[212:215], v[220:223], v[64:67], v[212:215]
    s_add_u32 m0, s59, 28672
    s_mov_b32 s98, 163840
    buffer_load_dwordx4 v252, s[92:95], s98 offen lds
    ds_read_b64_tr_b16 v[244:245], v19 offset:30720
    ds_read_b64_tr_b16 v[246:247], v19 offset:32000
    s_waitcnt lgkmcnt(10)
    v_mfma_f32_16x16x32_bf16 v[196:199], v[224:227], v[60:63], v[196:199]
    v_mfma_f32_16x16x32_bf16 v[216:219], v[224:227], v[64:67], v[216:219]
    ds_read_b64_tr_b16 v[220:221], v18 offset:35840
    ds_read_b64_tr_b16 v[222:223], v18 offset:37120
    s_waitcnt lgkmcnt(10)
    v_mfma_f32_16x16x32_bf16 v[180:183], v[228:231], v[68:71], v[180:183]
    v_mfma_f32_16x16x32_bf16 v[200:203], v[228:231], v[72:75], v[200:203]
    s_add_u32 m0, s59, 32768
    s_mov_b32 s98, 163840
    buffer_load_dwordx4 v253, s[92:95], s98 offen lds
    ds_read_b64_tr_b16 v[224:225], v18 offset:35880
    ds_read_b64_tr_b16 v[226:227], v18 offset:37160
    s_waitcnt lgkmcnt(10)
    v_mfma_f32_16x16x32_bf16 v[184:187], v[232:235], v[68:71], v[184:187]
    v_mfma_f32_16x16x32_bf16 v[204:207], v[232:235], v[72:75], v[204:207]
    s_add_u32 m0, s59, 36864
    s_mov_b32 s98, 163840
    buffer_load_dwordx4 v254, s[92:95], s98 offen lds
    ds_read_b64_tr_b16 v[228:229], v18 offset:35920
    ds_read_b64_tr_b16 v[230:231], v18 offset:37200
    s_waitcnt lgkmcnt(10)
    v_mfma_f32_16x16x32_bf16 v[188:191], v[236:239], v[68:71], v[188:191]
    v_mfma_f32_16x16x32_bf16 v[208:211], v[236:239], v[72:75], v[208:211]
    ds_read_b64_tr_b16 v[232:233], v18 offset:35960
    ds_read_b64_tr_b16 v[234:235], v18 offset:37240
    s_waitcnt lgkmcnt(10)
    v_mfma_f32_16x16x32_bf16 v[192:195], v[240:243], v[68:71], v[192:195]
    v_mfma_f32_16x16x32_bf16 v[212:215], v[240:243], v[72:75], v[212:215]
    s_add_u32 m0, s59, 40960
    s_mov_b32 s98, 327680
    buffer_load_dwordx4 v250, s[92:95], s98 offen lds
    ds_read_b64_tr_b16 v[236:237], v19 offset:35840
    ds_read_b64_tr_b16 v[238:239], v19 offset:37120
    s_waitcnt lgkmcnt(10)
    v_mfma_f32_16x16x32_bf16 v[196:199], v[244:247], v[68:71], v[196:199]
    v_mfma_f32_16x16x32_bf16 v[216:219], v[244:247], v[72:75], v[216:219]
    s_mov_b32 s99, 0
    s_waitcnt vmcnt(11)
L_rdy_1:
    v_cmp_eq_u32 vcc, 0, v249
    s_cbranch_vccz L_rdy_1x
    s_sleep 4
    global_load_dword v249, v248, s[28:29] offset:128 sc1
    s_add_u32 s99, s99, 1
    s_cmp_lt_u32 s99, 16384
    s_waitcnt vmcnt(0)
    s_cbranch_scc1 L_rdy_1
L_rdy_1x:

    s_barrier
    ds_read_b64_tr_b16 v[240:241], v18 offset:40960
    ds_read_b64_tr_b16 v[242:243], v18 offset:42240
    s_waitcnt lgkmcnt(10)
    v_mfma_f32_16x16x32_bf16 v[180:183], v[220:223], v[76:79], v[180:183]
    v_mfma_f32_16x16x32_bf16 v[200:203], v[220:223], v[80:83], v[200:203]
    ds_read_b64_tr_b16 v[244:245], v18 offset:41000
    ds_read_b64_tr_b16 v[246:247], v18 offset:42280
    s_waitcnt lgkmcnt(10)
    v_mfma_f32_16x16x32_bf16 v[184:187], v[224:227], v[76:79], v[184:187]
    v_mfma_f32_16x16x32_bf16 v[204:207], v[224:227], v[80:83], v[204:207]
    ds_read_b64_tr_b16 v[220:221], v18 offset:41040
    ds_read_b64_tr_b16 v[222:223], v18 offset:42320
    s_waitcnt lgkmcnt(10)
    v_mfma_f32_16x16x32_bf16 v[188:191], v[228:231], v[76:79], v[188:191]
    v_mfma_f32_16x16x32_bf16 v[208:211], v[228:231], v[80:83], v[208:211]
    ds_read_b64_tr_b16 v[224:225], v18 offset:41080
    ds_read_b64_tr_b16 v[226:227], v18 offset:42360
    s_waitcnt lgkmcnt(10)
    v_mfma_f32_16x16x32_bf16 v[192:195], v[232:235], v[76:79], v[192:195]
    v_mfma_f32_16x16x32_bf16 v[212:215], v[232:235], v[80:83], v[212:215]
    ds_read_b64_tr_b16 v[228:229], v19 offset:40960
    ds_read_b64_tr_b16 v[230:231], v19 offset:42240
    s_waitcnt lgkmcnt(10)
    v_mfma_f32_16x16x32_bf16 v[196:199], v[236:239], v[76:79], v[196:199]
    v_mfma_f32_16x16x32_bf16 v[216:219], v[236:239], v[80:83], v[216:219]
    ds_read_b64_tr_b16 v[232:233], v18 offset:46080
    ds_read_b64_tr_b16 v[234:235], v18 offset:47360
    s_waitcnt lgkmcnt(10)
    v_mfma_f32_16x16x32_bf16 v[180:183], v[240:243], v[84:87], v[180:183]
    v_mfma_f32_16x16x32_bf16 v[200:203], v[240:243], v[88:91], v[200:203]
    ds_read_b64_tr_b16 v[236:237], v18 offset:46120
    ds_read_b64_tr_b16 v[238:239], v18 offset:47400
    s_waitcnt lgkmcnt(10)
    v_mfma_f32_16x16x32_bf16 v[184:187], v[244:247], v[84:87], v[184:187]
    v_mfma_f32_16x16x32_bf16 v[204:207], v[244:247], v[88:91], v[204:207]
    ds_read_b64_tr_b16 v[240:241], v18 offset:46160
    ds_read_b64_tr_b16 v[242:243], v18 offset:47440
    s_waitcnt lgkmcnt(10)
    v_mfma_f32_16x16x32_bf16 v[188:191], v[220:223], v[84:87], v[188:191]
    v_mfma_f32_16x16x32_bf16 v[208:211], v[220:223], v[88:91], v[208:211]
    ds_read_b64_tr_b16 v[244:245], v18 offset:46200
    ds_read_b64_tr_b16 v[246:247], v18 offset:47480
    s_waitcnt lgkmcnt(10)
    v_mfma_f32_16x16x32_bf16 v[192:195], v[224:227], v[84:87], v[192:195]
    v_mfma_f32_16x16x32_bf16 v[212:215], v[224:227], v[88:91], v[212:215]
    ds_read_b64_tr_b16 v[220:221], v19 offset:46080
    ds_read_b64_tr_b16 v[222:223], v19 offset:47360
    s_waitcnt lgkmcnt(10)
    v_mfma_f32_16x16x32_bf16 v[196:199], v[228:231], v[84:87], v[196:199]
    v_mfma_f32_16x16x32_bf16 v[216:219], v[228:231], v[88:91], v[216:219]
    ds_read_b64_tr_b16 v[224:225], v17 offset:0
    ds_read_b64_tr_b16 v[226:227], v17 offset:1280
    s_waitcnt lgkmcnt(10)
    v_mfma_f32_16x16x32_bf16 v[180:183], v[232:235], v[92:95], v[180:183]
    v_mfma_f32_16x16x32_bf16 v[200:203], v[232:235], v[96:99], v[200:203]
    ds_read_b64_tr_b16 v[228:229], v17 offset:5120
    ds_read_b64_tr_b16 v[230:231], v17 offset:6400
    s_waitcnt lgkmcnt(10)
    v_mfma_f32_16x16x32_bf16 v[184:187], v[236:239], v[92:95], v[184:187]
    v_mfma_f32_16x16x32_bf16 v[204:207], v[236:239], v[96:99], v[204:207]
    ds_read_b64_tr_b16 v[232:233], v17 offset:10240
    ds_read_b64_tr_b16 v[234:235], v17 offset:11520
    s_waitcnt lgkmcnt(10)
    v_mfma_f32_16x16x32_bf16 v[188:191], v[240:243], v[92:95], v[188:191]
    v_mfma_f32_16x16x32_bf16 v[208:211], v[240:243], v[96:99], v[208:211]
    ds_read_b64_tr_b16 v[236:237], v17 offset:15360
    ds_read_b64_tr_b16 v[238:239], v17 offset:16640
    s_waitcnt lgkmcnt(10)
    v_mfma_f32_16x16x32_bf16 v[192:195], v[244:247], v[92:95], v[192:195]
    v_mfma_f32_16x16x32_bf16 v[212:215], v[244:247], v[96:99], v[212:215]
    ds_read_b64_tr_b16 v[240:241], v17 offset:20480
    ds_read_b64_tr_b16 v[242:243], v17 offset:21760
    s_waitcnt lgkmcnt(10)
    v_mfma_f32_16x16x32_bf16 v[196:199], v[220:223], v[92:95], v[196:199]
    v_mfma_f32_16x16x32_bf16 v[216:219], v[220:223], v[96:99], v[216:219]
    ds_read_b64_tr_b16 v[244:245], v17 offset:25600
    ds_read_b64_tr_b16 v[246:247], v17 offset:26880
    s_waitcnt lgkmcnt(10)
    v_mfma_f32_16x16x32_bf16 v[196:199], v[224:227], v[100:103], v[196:199]
    v_mfma_f32_16x16x32_bf16 v[216:219], v[224:227], v[104:107], v[216:219]
    s_barrier
    ds_read_b64_tr_b16 v[220:221], v17 offset:30720
    ds_read_b64_tr_b16 v[222:223], v17 offset:32000
    s_waitcnt lgkmcnt(10)
    v_mfma_f32_16x16x32_bf16 v[196:199], v[228:231], v[108:111], v[196:199]
    v_mul_u32_u24 v9, 40, v5
    v_add_u32 v9, 51200, v9
    v_mfma_f32_16x16x32_bf16 v[216:219], v[228:231], v[112:115], v[216:219]
    ds_read_b64_tr_b16 v[224:225], v17 offset:35840
    ds_read_b64_tr_b16 v[226:227], v17 offset:37120
    v_lshl_add_u32 v8, v6, 3, v9
    v_lshrrev_b32 v11, 2, v5
    s_waitcnt lgkmcnt(10)
    v_mfma_f32_16x16x32_bf16 v[196:199], v[232:235], v[116:119], v[196:199]
    v_cmp_eq_u32 vcc, 0, v7
    v_mov_b32 v12, 4
    v_mfma_f32_16x16x32_bf16 v[216:219], v[232:235], v[120:123], v[216:219]
    ds_read_b64_tr_b16 v[228:229], v17 offset:40960
    ds_read_b64_tr_b16 v[230:231], v17 offset:42240
    v_cmp_eq_u32 s[44:45], 0, v6
    v_cndmask_b32 v11, v12, v11, vcc
    s_waitcnt lgkmcnt(10)
    v_mfma_f32_16x16x32_bf16 v[196:199], v[236:239], v[124:127], v[196:199]
    v_cmp_eq_u32 s[46:47], 1, v6
    v_mul_u32_u24 v11, 40, v11
    v_mfma_f32_16x16x32_bf16 v[216:219], v[236:239], v[128:131], v[216:219]
    ds_read_b64_tr_b16 v[232:233], v17 offset:46080
    ds_read_b64_tr_b16 v[234:235], v17 offset:47360
    v_cmp_eq_u32 s[48:49], 2, v6
    v_add_u32 v11, 51840, v11
    s_waitcnt lgkmcnt(10)
    v_mfma_f32_16x16x32_bf16 v[196:199], v[240:243], v[132:135], v[196:199]
    v_cmp_eq_u32 s[56:57], 3, v6
    v_lshl_add_u32 v10, v6, 3, v11
    v_mfma_f32_16x16x32_bf16 v[216:219], v[240:243], v[136:139], v[216:219]
    ds_read_b64_tr_b16 v[236:237], v3 offset:0
    ds_read_b64_tr_b16 v[238:239], v3 offset:1280
    v_lshlrev_b32 v12, 4, v1
    v_lshlrev_b32 v13, 3, v1
    s_waitcnt lgkmcnt(10)
    v_mfma_f32_16x16x32_bf16 v[196:199], v[244:247], v[140:143], v[196:199]
    s_lshl_b32 s54, s50, 3
    s_lshl_b32 s55, s51, 1
    v_mfma_f32_16x16x32_bf16 v[216:219], v[244:247], v[144:147], v[216:219]
    ds_read_b64_tr_b16 v[240:241], v3 offset:5120
    ds_read_b64_tr_b16 v[242:243], v3 offset:6400
    s_add_u32 s54, s54, s55
    s_lshl_b32 s54, s54, 3
    s_waitcnt lgkmcnt(10)
    v_mfma_f32_16x16x32_bf16 v[196:199], v[220:223], v[148:151], v[196:199]
    s_add_u32 s54, s54, s52
    s_mul_i32 s54, s54, 2560
    v_mfma_f32_16x16x32_bf16 v[216:219], v[220:223], v[152:155], v[216:219]
    ds_read_b64_tr_b16 v[244:245], v3 offset:10240
    ds_read_b64_tr_b16 v[246:247], v3 offset:11520
    s_add_u32 s54, s54, 2621440
    s_add_u32 s55, s54, 20480
    s_waitcnt lgkmcnt(10)
    v_mfma_f32_16x16x32_bf16 v[196:199], v[224:227], v[156:159], v[196:199]
    s_lshl_b32 s3, s50, 3
    s_add_u32 s3, s3, s52
    v_mfma_f32_16x16x32_bf16 v[216:219], v[224:227], v[160:163], v[216:219]
    ds_read_b64_tr_b16 v[220:221], v3 offset:15360
    ds_read_b64_tr_b16 v[222:223], v3 offset:16640
    s_lshl_b32 s3, s3, 7
    s_add_u32 s3, s3, 5783552
    s_waitcnt lgkmcnt(10)
    v_mfma_f32_16x16x32_bf16 v[196:199], v[228:231], v[164:167], v[196:199]
    v_lshlrev_b32 v16, 23, v255
    s_mov_b32 s58, 110640
    v_mfma_f32_16x16x32_bf16 v[216:219], v[228:231], v[168:171], v[216:219]
    ds_read_b64_tr_b16 v[224:225], v3 offset:20480
    ds_read_b64_tr_b16 v[226:227], v3 offset:21760
    s_waitcnt lgkmcnt(10)
    v_mfma_f32_16x16x32_bf16 v[196:199], v[232:235], v[172:175], v[196:199]
    v_mfma_f32_16x16x32_bf16 v[216:219], v[232:235], v[176:179], v[216:219]
    ds_read_b64_tr_b16 v[228:229], v3 offset:25600
    ds_read_b64_tr_b16 v[230:231], v3 offset:26880
    s_waitcnt lgkmcnt(10)
    v_mfma_f32_16x16x32_bf16 v[180:183], v[236:239], v[100:103], v[180:183]
    v_mfma_f32_16x16x32_bf16 v[200:203], v[236:239], v[104:107], v[200:203]
    ds_read_b64_tr_b16 v[232:233], v3 offset:30720
    ds_read_b64_tr_b16 v[234:235], v3 offset:32000
    s_waitcnt lgkmcnt(10)
    v_mfma_f32_16x16x32_bf16 v[180:183], v[240:243], v[108:111], v[180:183]
    v_mul_f32 v52, s60, v196
    v_mul_f32 v53, s60, v197
    v_mfma_f32_16x16x32_bf16 v[200:203], v[240:243], v[112:115], v[200:203]
    ds_read_b64_tr_b16 v[236:237], v3 offset:35840
    ds_read_b64_tr_b16 v[238:239], v3 offset:37120
    v_mul_f32 v54, s60, v198
    v_mul_f32 v55, s60, v199
    s_waitcnt lgkmcnt(10)
    v_mfma_f32_16x16x32_bf16 v[180:183], v[244:247], v[116:119], v[180:183]
    v_exp_f32 v52, v52 clamp
    v_max_f32 v196, s61, v196
    v_mfma_f32_16x16x32_bf16 v[200:203], v[244:247], v[120:123], v[200:203]
    ds_read_b64_tr_b16 v[240:241], v3 offset:40960
    ds_read_b64_tr_b16 v[242:243], v3 offset:42240
    v_exp_f32 v53, v53 clamp
    v_max_f32 v197, s61, v197
    s_waitcnt lgkmcnt(10)
    v_mfma_f32_16x16x32_bf16 v[180:183], v[220:223], v[124:127], v[180:183]
    v_exp_f32 v54, v54 clamp
    v_max_f32 v198, s61, v198
    v_mfma_f32_16x16x32_bf16 v[200:203], v[220:223], v[128:131], v[200:203]
    ds_read_b64_tr_b16 v[244:245], v3 offset:46080
    ds_read_b64_tr_b16 v[246:247], v3 offset:47360
    v_exp_f32 v55, v55 clamp
    v_max_f32 v199, s61, v199
    s_waitcnt lgkmcnt(10)
    v_mfma_f32_16x16x32_bf16 v[180:183], v[224:227], v[132:135], v[180:183]
    v_add_f32 v196, v196, v52
    v_add_f32 v197, v197, v53
    v_mfma_f32_16x16x32_bf16 v[200:203], v[224:227], v[136:139], v[200:203]
    ds_read_b64_tr_b16 v[220:221], v3 offset:40
    ds_read_b64_tr_b16 v[222:223], v3 offset:1320
    v_add_f32 v198, v198, v54
    v_add_f32 v199, v199, v55
    s_waitcnt lgkmcnt(10)
    v_mfma_f32_16x16x32_bf16 v[180:183], v[228:231], v[140:143], v[180:183]
    v_cvt_pk_bf16_f32 v14, v196, v197
    v_cvt_pk_bf16_f32 v15, v198, v199
    v_mfma_f32_16x16x32_bf16 v[200:203], v[228:231], v[144:147], v[200:203]
    ds_read_b64_tr_b16 v[224:225], v3 offset:5160
    ds_read_b64_tr_b16 v[226:227], v3 offset:6440
    v_cndmask_b32 v22, 0, v14, s[44:45]
    v_cndmask_b32 v23, 0, v15, s[44:45]
    s_waitcnt lgkmcnt(10)
    v_mfma_f32_16x16x32_bf16 v[180:183], v[232:235], v[148:151], v[180:183]
    v_cndmask_b32 v26, 0, v14, s[46:47]
    v_cndmask_b32 v27, 0, v15, s[46:47]
    v_mfma_f32_16x16x32_bf16 v[200:203], v[232:235], v[152:155], v[200:203]
    ds_read_b64_tr_b16 v[228:229], v3 offset:10280
    ds_read_b64_tr_b16 v[230:231], v3 offset:11560
    v_cndmask_b32 v30, 0, v14, s[48:49]
    v_cndmask_b32 v31, 0, v15, s[48:49]
    s_waitcnt lgkmcnt(10)
    v_mfma_f32_16x16x32_bf16 v[180:183], v[236:239], v[156:159], v[180:183]
    v_cndmask_b32 v34, 0, v14, s[56:57]
    v_cndmask_b32 v35, 0, v15, s[56:57]
    v_mfma_f32_16x16x32_bf16 v[200:203], v[236:239], v[160:163], v[200:203]
    ds_read_b64_tr_b16 v[232:233], v3 offset:15400
    ds_read_b64_tr_b16 v[234:235], v3 offset:16680
    v_mul_f32 v56, s60, v216
    v_mul_f32 v57, s60, v217
    s_waitcnt lgkmcnt(10)
    v_mfma_f32_16x16x32_bf16 v[180:183], v[240:243], v[164:167], v[180:183]
    v_mul_f32 v58, s60, v218
    v_mul_f32 v59, s60, v219
    v_mfma_f32_16x16x32_bf16 v[200:203], v[240:243], v[168:171], v[200:203]
    ds_read_b64_tr_b16 v[236:237], v3 offset:20520
    ds_read_b64_tr_b16 v[238:239], v3 offset:21800
    v_exp_f32 v56, v56 clamp
    v_max_f32 v216, s61, v216
    s_waitcnt lgkmcnt(10)
    v_mfma_f32_16x16x32_bf16 v[180:183], v[244:247], v[172:175], v[180:183]
    v_exp_f32 v57, v57 clamp
    v_max_f32 v217, s61, v217
    v_mfma_f32_16x16x32_bf16 v[200:203], v[244:247], v[176:179], v[200:203]
    ds_read_b64_tr_b16 v[240:241], v3 offset:25640
    ds_read_b64_tr_b16 v[242:243], v3 offset:26920
    v_exp_f32 v58, v58 clamp
    v_max_f32 v218, s61, v218
    s_waitcnt lgkmcnt(10)
    v_mfma_f32_16x16x32_bf16 v[184:187], v[220:223], v[100:103], v[184:187]
    v_exp_f32 v59, v59 clamp
    v_max_f32 v219, s61, v219
    v_mfma_f32_16x16x32_bf16 v[204:207], v[220:223], v[104:107], v[204:207]
    ds_read_b64_tr_b16 v[244:245], v3 offset:30760
    ds_read_b64_tr_b16 v[246:247], v3 offset:32040
    v_add_f32 v216, v216, v56
    v_add_f32 v217, v217, v57
    s_waitcnt lgkmcnt(10)
    v_mfma_f32_16x16x32_bf16 v[184:187], v[224:227], v[108:111], v[184:187]
    v_add_f32 v218, v218, v58
    v_add_f32 v219, v219, v59
    v_mfma_f32_16x16x32_bf16 v[204:207], v[224:227], v[112:115], v[204:207]
    ds_read_b64_tr_b16 v[220:221], v3 offset:35880
    ds_read_b64_tr_b16 v[222:223], v3 offset:37160
    v_cvt_pk_bf16_f32 v14, v216, v217
    v_cvt_pk_bf16_f32 v15, v218, v219
    s_waitcnt lgkmcnt(10)
    v_mfma_f32_16x16x32_bf16 v[184:187], v[228:231], v[116:119], v[184:187]
    v_cndmask_b32 v38, 0, v14, s[44:45]
    v_cndmask_b32 v39, 0, v15, s[44:45]
    v_mfma_f32_16x16x32_bf16 v[204:207], v[228:231], v[120:123], v[204:207]
    ds_read_b64_tr_b16 v[224:225], v3 offset:41000
    ds_read_b64_tr_b16 v[226:227], v3 offset:42280
    v_cndmask_b32 v42, 0, v14, s[46:47]
    v_cndmask_b32 v43, 0, v15, s[46:47]
    s_waitcnt lgkmcnt(10)
    v_mfma_f32_16x16x32_bf16 v[184:187], v[232:235], v[124:127], v[184:187]
    v_cndmask_b32 v46, 0, v14, s[48:49]
    v_cndmask_b32 v47, 0, v15, s[48:49]
    v_mfma_f32_16x16x32_bf16 v[204:207], v[232:235], v[128:131], v[204:207]
    ds_read_b64_tr_b16 v[228:229], v3 offset:46120
    ds_read_b64_tr_b16 v[230:231], v3 offset:47400
    v_cndmask_b32 v50, 0, v14, s[56:57]
    v_cndmask_b32 v51, 0, v15, s[56:57]
    s_waitcnt lgkmcnt(10)
    v_mfma_f32_16x16x32_bf16 v[184:187], v[236:239], v[132:135], v[184:187]
    v_mul_f32 v52, s60, v180
    v_mul_f32 v53, s60, v181
    v_mfma_f32_16x16x32_bf16 v[204:207], v[236:239], v[136:139], v[204:207]
    ds_read_b64_tr_b16 v[232:233], v3 offset:80
    ds_read_b64_tr_b16 v[234:235], v3 offset:1360
    v_mul_f32 v54, s60, v182
    v_mul_f32 v55, s60, v183
    s_waitcnt lgkmcnt(10)
    v_mfma_f32_16x16x32_bf16 v[184:187], v[240:243], v[140:143], v[184:187]
    v_exp_f32 v52, v52 clamp
    v_max_f32 v180, s61, v180
    v_mfma_f32_16x16x32_bf16 v[204:207], v[240:243], v[144:147], v[204:207]
    ds_read_b64_tr_b16 v[236:237], v3 offset:5200
    ds_read_b64_tr_b16 v[238:239], v3 offset:6480
    v_exp_f32 v53, v53 clamp
    v_max_f32 v181, s61, v181
    s_waitcnt lgkmcnt(10)
    v_mfma_f32_16x16x32_bf16 v[184:187], v[244:247], v[148:151], v[184:187]
    v_exp_f32 v54, v54 clamp
    v_max_f32 v182, s61, v182
    v_mfma_f32_16x16x32_bf16 v[204:207], v[244:247], v[152:155], v[204:207]
    ds_read_b64_tr_b16 v[240:241], v3 offset:10320
    ds_read_b64_tr_b16 v[242:243], v3 offset:11600
    v_exp_f32 v55, v55 clamp
    v_max_f32 v183, s61, v183
    s_waitcnt lgkmcnt(10)
    v_mfma_f32_16x16x32_bf16 v[184:187], v[220:223], v[156:159], v[184:187]
    v_add_f32 v180, v180, v52
    v_add_f32 v181, v181, v53
    v_mfma_f32_16x16x32_bf16 v[204:207], v[220:223], v[160:163], v[204:207]
    ds_read_b64_tr_b16 v[244:245], v3 offset:15440
    ds_read_b64_tr_b16 v[246:247], v3 offset:16720
    v_add_f32 v182, v182, v54
    v_add_f32 v183, v183, v55
    s_waitcnt lgkmcnt(10)
    v_mfma_f32_16x16x32_bf16 v[184:187], v[224:227], v[164:167], v[184:187]
    v_cvt_pk_bf16_f32 v20, v180, v181
    v_cvt_pk_bf16_f32 v21, v182, v183
    v_mfma_f32_16x16x32_bf16 v[204:207], v[224:227], v[168:171], v[204:207]
    ds_read_b64_tr_b16 v[220:221], v3 offset:20560
    ds_read_b64_tr_b16 v[222:223], v3 offset:21840
    v_mul_f32 v56, s60, v200
    v_mul_f32 v57, s60, v201
    s_waitcnt lgkmcnt(10)
    v_mfma_f32_16x16x32_bf16 v[184:187], v[228:231], v[172:175], v[184:187]
    v_mul_f32 v58, s60, v202
    v_mul_f32 v59, s60, v203
    v_mfma_f32_16x16x32_bf16 v[204:207], v[228:231], v[176:179], v[204:207]
    ds_read_b64_tr_b16 v[224:225], v3 offset:25680
    ds_read_b64_tr_b16 v[226:227], v3 offset:26960
    v_exp_f32 v56, v56 clamp
    v_max_f32 v200, s61, v200
    s_waitcnt lgkmcnt(10)
    v_mfma_f32_16x16x32_bf16 v[188:191], v[232:235], v[100:103], v[188:191]
    v_exp_f32 v57, v57 clamp
    v_max_f32 v201, s61, v201
    v_mfma_f32_16x16x32_bf16 v[208:211], v[232:235], v[104:107], v[208:211]
    ds_read_b64_tr_b16 v[228:229], v3 offset:30800
    ds_read_b64_tr_b16 v[230:231], v3 offset:32080
    v_exp_f32 v58, v58 clamp
    v_max_f32 v202, s61, v202
    s_waitcnt lgkmcnt(10)
    v_mfma_f32_16x16x32_bf16 v[188:191], v[236:239], v[108:111], v[188:191]
    v_exp_f32 v59, v59 clamp
    v_max_f32 v203, s61, v203
    v_mfma_f32_16x16x32_bf16 v[208:211], v[236:239], v[112:115], v[208:211]
    ds_read_b64_tr_b16 v[232:233], v3 offset:35920
    ds_read_b64_tr_b16 v[234:235], v3 offset:37200
    v_add_f32 v200, v200, v56
    v_add_f32 v201, v201, v57
    s_waitcnt lgkmcnt(10)
    v_mfma_f32_16x16x32_bf16 v[188:191], v[240:243], v[116:119], v[188:191]
    v_add_f32 v202, v202, v58
    v_add_f32 v203, v203, v59
    v_mfma_f32_16x16x32_bf16 v[208:211], v[240:243], v[120:123], v[208:211]
    ds_read_b64_tr_b16 v[236:237], v3 offset:41040
    ds_read_b64_tr_b16 v[238:239], v3 offset:42320
    v_cvt_pk_bf16_f32 v36, v200, v201
    v_cvt_pk_bf16_f32 v37, v202, v203
    s_waitcnt lgkmcnt(10)
    v_mfma_f32_16x16x32_bf16 v[188:191], v[244:247], v[124:127], v[188:191]
    v_mul_f32 v52, s60, v184
    v_mul_f32 v53, s60, v185
    v_mfma_f32_16x16x32_bf16 v[208:211], v[244:247], v[128:131], v[208:211]
    ds_read_b64_tr_b16 v[240:241], v3 offset:46160
    ds_read_b64_tr_b16 v[242:243], v3 offset:47440
    v_mul_f32 v54, s60, v186
    v_mul_f32 v55, s60, v187
    s_waitcnt lgkmcnt(10)
    v_mfma_f32_16x16x32_bf16 v[188:191], v[220:223], v[132:135], v[188:191]
    v_exp_f32 v52, v52 clamp
    v_max_f32 v184, s61, v184
    v_mfma_f32_16x16x32_bf16 v[208:211], v[220:223], v[136:139], v[208:211]
    ds_read_b64_tr_b16 v[244:245], v3 offset:120
    ds_read_b64_tr_b16 v[246:247], v3 offset:1400
    v_exp_f32 v53, v53 clamp
    v_max_f32 v185, s61, v185
    s_waitcnt lgkmcnt(10)
    v_mfma_f32_16x16x32_bf16 v[188:191], v[224:227], v[140:143], v[188:191]
    v_exp_f32 v54, v54 clamp
    v_max_f32 v186, s61, v186
    v_mfma_f32_16x16x32_bf16 v[208:211], v[224:227], v[144:147], v[208:211]
    ds_read_b64_tr_b16 v[220:221], v3 offset:5240
    ds_read_b64_tr_b16 v[222:223], v3 offset:6520
    v_exp_f32 v55, v55 clamp
    v_max_f32 v187, s61, v187
    s_waitcnt lgkmcnt(10)
    v_mfma_f32_16x16x32_bf16 v[188:191], v[228:231], v[148:151], v[188:191]
    v_add_f32 v184, v184, v52
    v_add_f32 v185, v185, v53
    v_mfma_f32_16x16x32_bf16 v[208:211], v[228:231], v[152:155], v[208:211]
    ds_read_b64_tr_b16 v[224:225], v3 offset:10360
    ds_read_b64_tr_b16 v[226:227], v3 offset:11640
    v_add_f32 v186, v186, v54
    v_add_f32 v187, v187, v55
    s_waitcnt lgkmcnt(10)
    v_mfma_f32_16x16x32_bf16 v[188:191], v[232:235], v[156:159], v[188:191]
    v_cvt_pk_bf16_f32 v24, v184, v185
    v_cvt_pk_bf16_f32 v25, v186, v187
    v_mfma_f32_16x16x32_bf16 v[208:211], v[232:235], v[160:163], v[208:211]
    ds_read_b64_tr_b16 v[228:229], v3 offset:15480
    ds_read_b64_tr_b16 v[230:231], v3 offset:16760
    v_mul_f32 v56, s60, v204
    v_mul_f32 v57, s60, v205
    s_waitcnt lgkmcnt(10)
    v_mfma_f32_16x16x32_bf16 v[188:191], v[236:239], v[164:167], v[188:191]
    v_mul_f32 v58, s60, v206
    v_mul_f32 v59, s60, v207
    v_mfma_f32_16x16x32_bf16 v[208:211], v[236:239], v[168:171], v[208:211]
    ds_read_b64_tr_b16 v[232:233], v3 offset:20600
    ds_read_b64_tr_b16 v[234:235], v3 offset:21880
    v_exp_f32 v56, v56 clamp
    v_max_f32 v204, s61, v204
    s_waitcnt lgkmcnt(10)
    v_mfma_f32_16x16x32_bf16 v[188:191], v[240:243], v[172:175], v[188:191]
    v_exp_f32 v57, v57 clamp
    v_max_f32 v205, s61, v205
    v_mfma_f32_16x16x32_bf16 v[208:211], v[240:243], v[176:179], v[208:211]
    ds_read_b64_tr_b16 v[236:237], v3 offset:25720
    ds_read_b64_tr_b16 v[238:239], v3 offset:27000
    v_exp_f32 v58, v58 clamp
    v_max_f32 v206, s61, v206
    s_waitcnt lgkmcnt(10)
    v_mfma_f32_16x16x32_bf16 v[192:195], v[244:247], v[100:103], v[192:195]
    v_exp_f32 v59, v59 clamp
    v_max_f32 v207, s61, v207
    v_mfma_f32_16x16x32_bf16 v[212:215], v[244:247], v[104:107], v[212:215]
    ds_read_b64_tr_b16 v[240:241], v3 offset:30840
    ds_read_b64_tr_b16 v[242:243], v3 offset:32120
    v_add_f32 v204, v204, v56
    v_add_f32 v205, v205, v57
    s_waitcnt lgkmcnt(10)
    v_mfma_f32_16x16x32_bf16 v[192:195], v[220:223], v[108:111], v[192:195]
    v_add_f32 v206, v206, v58
    v_add_f32 v207, v207, v59
    v_mfma_f32_16x16x32_bf16 v[212:215], v[220:223], v[112:115], v[212:215]
    ds_read_b64_tr_b16 v[244:245], v3 offset:35960
    ds_read_b64_tr_b16 v[246:247], v3 offset:37240
    v_cvt_pk_bf16_f32 v40, v204, v205
    v_cvt_pk_bf16_f32 v41, v206, v207
    s_waitcnt lgkmcnt(10)
    v_mfma_f32_16x16x32_bf16 v[192:195], v[224:227], v[116:119], v[192:195]
    v_mul_f32 v52, s60, v188
    v_mul_f32 v53, s60, v189
    v_mfma_f32_16x16x32_bf16 v[212:215], v[224:227], v[120:123], v[212:215]
    ds_read_b64_tr_b16 v[220:221], v3 offset:41080
    ds_read_b64_tr_b16 v[222:223], v3 offset:42360
    v_mul_f32 v54, s60, v190
    v_mul_f32 v55, s60, v191
    s_waitcnt lgkmcnt(10)
    v_mfma_f32_16x16x32_bf16 v[192:195], v[228:231], v[124:127], v[192:195]
    v_exp_f32 v52, v52 clamp
    v_max_f32 v188, s61, v188
    v_mfma_f32_16x16x32_bf16 v[212:215], v[228:231], v[128:131], v[212:215]
    ds_read_b64_tr_b16 v[224:225], v3 offset:46200
    ds_read_b64_tr_b16 v[226:227], v3 offset:47480
    v_exp_f32 v53, v53 clamp
    v_max_f32 v189, s61, v189
    s_waitcnt lgkmcnt(10)
    v_mfma_f32_16x16x32_bf16 v[192:195], v[232:235], v[132:135], v[192:195]
    v_exp_f32 v54, v54 clamp
    v_max_f32 v190, s61, v190
    v_mfma_f32_16x16x32_bf16 v[212:215], v[232:235], v[136:139], v[212:215]
    v_exp_f32 v55, v55 clamp
    v_max_f32 v191, s61, v191
    s_waitcnt lgkmcnt(8)
    v_mfma_f32_16x16x32_bf16 v[192:195], v[236:239], v[140:143], v[192:195]
    v_add_f32 v188, v188, v52
    v_add_f32 v189, v189, v53
    v_mfma_f32_16x16x32_bf16 v[212:215], v[236:239], v[144:147], v[212:215]
    v_add_f32 v190, v190, v54
    v_add_f32 v191, v191, v55
    s_waitcnt lgkmcnt(6)
    v_mfma_f32_16x16x32_bf16 v[192:195], v[240:243], v[148:151], v[192:195]
    v_cvt_pk_bf16_f32 v28, v188, v189
    v_cvt_pk_bf16_f32 v29, v190, v191
    v_mfma_f32_16x16x32_bf16 v[212:215], v[240:243], v[152:155], v[212:215]
    v_mul_f32 v56, s60, v208
    v_mul_f32 v57, s60, v209
    s_waitcnt lgkmcnt(4)
    v_mfma_f32_16x16x32_bf16 v[192:195], v[244:247], v[156:159], v[192:195]
    v_mul_f32 v58, s60, v210
    v_mul_f32 v59, s60, v211
    v_mfma_f32_16x16x32_bf16 v[212:215], v[244:247], v[160:163], v[212:215]
    v_exp_f32 v56, v56 clamp
    v_max_f32 v208, s61, v208
    s_waitcnt lgkmcnt(2)
    v_mfma_f32_16x16x32_bf16 v[192:195], v[220:223], v[164:167], v[192:195]
    v_exp_f32 v57, v57 clamp
    v_max_f32 v209, s61, v209
    v_mfma_f32_16x16x32_bf16 v[212:215], v[220:223], v[168:171], v[212:215]
    v_exp_f32 v58, v58 clamp
    v_max_f32 v210, s61, v210
    s_waitcnt lgkmcnt(0)
    v_mfma_f32_16x16x32_bf16 v[192:195], v[224:227], v[172:175], v[192:195]
    v_exp_f32 v59, v59 clamp
    v_max_f32 v211, s61, v211
    v_mfma_f32_16x16x32_bf16 v[212:215], v[224:227], v[176:179], v[212:215]
    v_add_f32 v208, v208, v56
    v_add_f32 v209, v209, v57
    s_mov_b32 s59, 59648
    s_nop 6
    v_add_f32 v210, v210, v58
    v_add_f32 v211, v211, v59
    v_cvt_pk_bf16_f32 v44, v208, v209
    v_cvt_pk_bf16_f32 v45, v210, v211
    v_mul_f32 v52, s60, v192
    v_mul_f32 v53, s60, v193
    v_mul_f32 v54, s60, v194
    v_mul_f32 v55, s60, v195
    v_exp_f32 v52, v52 clamp
    v_max_f32 v192, s61, v192
    v_exp_f32 v53, v53 clamp
    v_max_f32 v193, s61, v193
    v_exp_f32 v54, v54 clamp
    v_max_f32 v194, s61, v194
    v_exp_f32 v55, v55 clamp
    v_max_f32 v195, s61, v195
    v_add_f32 v192, v192, v52
    v_add_f32 v193, v193, v53
    v_add_f32 v194, v194, v54
    v_add_f32 v195, v195, v55
    v_cvt_pk_bf16_f32 v32, v192, v193
    v_cvt_pk_bf16_f32 v33, v194, v195
    v_mul_f32 v56, s60, v212
    v_mul_f32 v57, s60, v213
    v_mul_f32 v58, s60, v214
    v_mul_f32 v59, s60, v215
    v_exp_f32 v56, v56 clamp
    v_max_f32 v212, s61, v212
    v_exp_f32 v57, v57 clamp
    v_max_f32 v213, s61, v213
    v_exp_f32 v58, v58 clamp
    v_max_f32 v214, s61, v214
    v_exp_f32 v59, v59 clamp
    v_max_f32 v215, s61, v215
    v_add_f32 v212, v212, v56
    v_add_f32 v213, v213, v57
    v_add_f32 v214, v214, v58
    v_add_f32 v215, v215, v59
    v_cvt_pk_bf16_f32 v48, v212, v213
    v_cvt_pk_bf16_f32 v49, v214, v215
    s_waitcnt vmcnt(0)
    s_barrier
    buffer_store_dword v16, v16, s[40:43], s3 offen sc1
    ds_read_b64 v[56:57], v10 offset:0
    ds_read_b64 v[58:59], v11 offset:32
    ds_read_b64 v[52:53], v8 offset:0
    ds_read_b64 v[54:55], v9 offset:32

    ds_read_b64 v[64:65], v10 offset:840
    ds_read_b64 v[66:67], v11 offset:872
    ds_read_b64 v[60:61], v8 offset:840
    ds_read_b64 v[62:63], v9 offset:872

    ds_read_b64 v[72:73], v10 offset:1680
    ds_read_b64 v[74:75], v11 offset:1712
    ds_read_b64 v[68:69], v8 offset:1680
    ds_read_b64 v[70:71], v9 offset:1712

    ds_read_b64 v[80:81], v10 offset:2520
    ds_read_b64 v[82:83], v11 offset:2552
    ds_read_b64 v[76:77], v8 offset:2520
    ds_read_b64 v[78:79], v9 offset:2552

    s_waitcnt lgkmcnt(12)
    v_mfma_f32_16x16x32_bf16 v[88:91], v[56:59], v[20:23], 0
    v_mfma_f32_16x16x32_bf16 v[120:123], v[56:59], v[36:39], 0
    v_mfma_f32_16x16x32_bf16 v[84:87], v[52:55], v[20:23], 0
    v_mfma_f32_16x16x32_bf16 v[116:119], v[52:55], v[36:39], 0
    s_waitcnt lgkmcnt(8)
    v_mfma_f32_16x16x32_bf16 v[96:99], v[64:67], v[24:27], 0
    v_mfma_f32_16x16x32_bf16 v[128:131], v[64:67], v[40:43], 0
    v_mfma_f32_16x16x32_bf16 v[92:95], v[60:63], v[24:27], 0
    v_mfma_f32_16x16x32_bf16 v[124:127], v[60:63], v[40:43], 0
    s_waitcnt lgkmcnt(4)
    v_mfma_f32_16x16x32_bf16 v[104:107], v[72:75], v[28:31], 0
    v_mfma_f32_16x16x32_bf16 v[136:139], v[72:75], v[44:47], 0
    v_mfma_f32_16x16x32_bf16 v[100:103], v[68:71], v[28:31], 0
    v_mfma_f32_16x16x32_bf16 v[132:135], v[68:71], v[44:47], 0
    s_waitcnt lgkmcnt(0)
    v_mfma_f32_16x16x32_bf16 v[112:115], v[80:83], v[32:35], 0
    v_mfma_f32_16x16x32_bf16 v[144:147], v[80:83], v[48:51], 0
    v_mfma_f32_16x16x32_bf16 v[108:111], v[76:79], v[32:35], 0
    v_mfma_f32_16x16x32_bf16 v[140:143], v[76:79], v[48:51], 0
    s_nop 1
    v_add_f32 v89, s61, v89
    v_add_f32 v97, s61, v97
    v_add_f32 v105, s61, v105
    v_add_f32 v113, s61, v113
    v_rcp_f32 v89, v89
    v_rcp_f32 v97, v97
    v_rcp_f32 v105, v105
    v_rcp_f32 v113, v113
    v_mul_f32 v84, v84, v89
    v_mul_f32 v85, v85, v89
    v_mul_f32 v86, v86, v89
    v_mul_f32 v87, v87, v89
    v_mul_f32 v88, v88, v89
    v_cvt_pk_bf16_f32 v148, v84, v85
    v_cvt_pk_bf16_f32 v149, v86, v87
    v_mul_f32 v92, v92, v97
    v_mul_f32 v93, v93, v97
    v_mul_f32 v94, v94, v97
    v_mul_f32 v95, v95, v97
    v_mul_f32 v96, v96, v97
    v_cvt_pk_bf16_f32 v150, v92, v93
    v_cvt_pk_bf16_f32 v151, v94, v95
    v_cvt_pk_bf16_f32 v156, v88, v96
    buffer_store_dwordx4 v[148:151], v12, s[40:43], s54 offen offset:0 sc1
    v_mul_f32 v100, v100, v105
    v_mul_f32 v101, v101, v105
    v_mul_f32 v102, v102, v105
    v_mul_f32 v103, v103, v105
    v_mul_f32 v104, v104, v105
    v_cvt_pk_bf16_f32 v152, v100, v101
    v_cvt_pk_bf16_f32 v153, v102, v103
    v_mul_f32 v108, v108, v113
    v_mul_f32 v109, v109, v113
    v_mul_f32 v110, v110, v113
    v_mul_f32 v111, v111, v113
    v_mul_f32 v112, v112, v113
    v_cvt_pk_bf16_f32 v154, v108, v109
    v_cvt_pk_bf16_f32 v155, v110, v111
    v_cvt_pk_bf16_f32 v157, v104, v112
    buffer_store_dwordx4 v[152:155], v12, s[40:43], s54 offen offset:1024 sc1
    buffer_store_dwordx2 v[156:157], v13, s[40:43], s54 offen offset:2048 sc1
    v_add_f32 v121, s61, v121
    v_add_f32 v129, s61, v129
    v_add_f32 v137, s61, v137
    v_add_f32 v145, s61, v145
    v_rcp_f32 v121, v121
    v_rcp_f32 v129, v129
    v_rcp_f32 v137, v137
    v_rcp_f32 v145, v145
    v_mul_f32 v116, v116, v121
    v_mul_f32 v117, v117, v121
    v_mul_f32 v118, v118, v121
    v_mul_f32 v119, v119, v121
    v_mul_f32 v120, v120, v121
    v_cvt_pk_bf16_f32 v160, v116, v117
    v_cvt_pk_bf16_f32 v161, v118, v119
    v_mul_f32 v124, v124, v129
    v_mul_f32 v125, v125, v129
    v_mul_f32 v126, v126, v129
    v_mul_f32 v127, v127, v129
    v_mul_f32 v128, v128, v129
    v_cvt_pk_bf16_f32 v162, v124, v125
    v_cvt_pk_bf16_f32 v163, v126, v127
    v_cvt_pk_bf16_f32 v168, v120, v128
    buffer_store_dwordx4 v[160:163], v12, s[40:43], s55 offen offset:0 sc1
    v_mul_f32 v132, v132, v137
    v_mul_f32 v133, v133, v137
    v_mul_f32 v134, v134, v137
    v_mul_f32 v135, v135, v137
    v_mul_f32 v136, v136, v137
    v_cvt_pk_bf16_f32 v164, v132, v133
    v_cvt_pk_bf16_f32 v165, v134, v135
    v_mul_f32 v140, v140, v145
    v_mul_f32 v141, v141, v145
    v_mul_f32 v142, v142, v145
    v_mul_f32 v143, v143, v145
    v_mul_f32 v144, v144, v145
    v_cvt_pk_bf16_f32 v166, v140, v141
    v_cvt_pk_bf16_f32 v167, v142, v143
    v_cvt_pk_bf16_f32 v169, v136, v144
    buffer_store_dwordx4 v[164:167], v12, s[40:43], s55 offen offset:1024 sc1
    buffer_store_dwordx2 v[168:169], v13, s[40:43], s55 offen offset:2048 sc1
    s_branch FIN
G_kv:
    v_and_b32 v5, 15, v1
    v_lshrrev_b32 v6, 4, v1
    v_and_b32 v7, 3, v1
    v_lshrrev_b32 v2, 1, v5
    v_xor_b32 v2, v2, v6
    v_lshlrev_b32 v2, 4, v2
    v_lshl_add_u32 v2, v5, 7, v2
    v_bfe_u32 v3, v1, 2, 3
    v_lshrrev_b32 v4, 5, v1
    v_lshl_add_u32 v3, v4, 4, v3
    v_mul_u32_u24 v3, 160, v3

    s_and_b32 s54, s51, 1
    s_lshr_b32 s55, s51, 1
    s_lshl_b32 s56, s54, 13
    v_add_u32 v8, s56, v2
    v_xor_b32 v9, 64, v8
    s_mul_i32 s56, s55, 80
    s_add_u32 s56, s56, 16384
    v_lshl_add_u32 v10, v7, 3, v3
    v_add_u32 v10, s56, v10
    v_lshrrev_b32 v4, 1, v7
    v_cmp_eq_u32 vcc, s55, v4
    v_and_b32 v4, 1, v7
    v_mul_u32_u24 v4, 40, v4
    v_mov_b32 v11, 10288
    v_cndmask_b32 v11, v11, 32, vcc
    v_add3_u32 v11, v11, v4, v3
    v_add_u32 v11, s56, v11
    s_mov_b32 s57, 0
    s_mov_b32 s58, 0

    v_mov_b32 v16, 0
    v_mov_b32 v17, 0
    v_mov_b32 v18, 0
    v_mov_b32 v19, 0
    v_mov_b32 v20, 0
    v_mov_b32 v21, 0
    v_mov_b32 v22, 0
    v_mov_b32 v23, 0
    v_mov_b32 v24, 0
    v_mov_b32 v25, 0
    v_mov_b32 v26, 0
    v_mov_b32 v27, 0
    v_mov_b32 v28, 0
    v_mov_b32 v29, 0
    v_mov_b32 v30, 0
    v_mov_b32 v31, 0
    v_mov_b32 v32, 0
    v_mov_b32 v33, 0
    v_mov_b32 v34, 0
    v_mov_b32 v35, 0
    v_mov_b32 v36, 0
    v_mov_b32 v37, 0
    v_mov_b32 v38, 0
    v_mov_b32 v39, 0
    v_mov_b32 v40, 0
    v_mov_b32 v41, 0
    v_mov_b32 v42, 0
    v_mov_b32 v43, 0
    v_mov_b32 v44, 0
    v_mov_b32 v45, 0
    v_mov_b32 v46, 0
    v_mov_b32 v47, 0
    v_mov_b32 v48, 0
    v_mov_b32 v49, 0
    v_mov_b32 v50, 0
    v_mov_b32 v51, 0
    v_mov_b32 v52, 0
    v_mov_b32 v53, 0
    v_mov_b32 v54, 0
    v_mov_b32 v55, 0
    v_mov_b32 v56, 0
    v_mov_b32 v57, 0
    v_mov_b32 v58, 0
    v_mov_b32 v59, 0
    v_mov_b32 v60, 0
    v_mov_b32 v61, 0
    v_mov_b32 v62, 0
    v_mov_b32 v63, 0
    v_mov_b32 v64, 0
    v_mov_b32 v65, 0
    v_mov_b32 v66, 0
    v_mov_b32 v67, 0
    v_mov_b32 v68, 0
    v_mov_b32 v69, 0
    v_mov_b32 v70, 0
    v_mov_b32 v71, 0
    v_mov_b32 v72, 0
    v_mov_b32 v73, 0
    v_mov_b32 v74, 0
    v_mov_b32 v75, 0
    v_mov_b32 v76, 0
    v_mov_b32 v77, 0
    v_mov_b32 v78, 0
    v_mov_b32 v79, 0
    v_mov_b32 v80, 0
    v_mov_b32 v81, 0
    v_mov_b32 v82, 0
    v_mov_b32 v83, 0
    v_mov_b32 v84, 0
    v_mov_b32 v85, 0
    v_mov_b32 v86, 0
    v_mov_b32 v87, 0
    v_mov_b32 v88, 0
    v_mov_b32 v89, 0
    v_mov_b32 v90, 0
    v_mov_b32 v91, 0
    v_mov_b32 v92, 0
    v_mov_b32 v93, 0
    v_mov_b32 v94, 0
    v_mov_b32 v95, 0
    s_mul_i32 s3, s55, 210
    v_mul_u32_u24 v12, 5, v5
    v_add_u32 v12, s3, v12
    v_lshrrev_b32 v13, 3, v5
    v_cmp_eq_u32 s[94:95], s55, v13
    v_and_b32 v14, 1, v6
    v_mul_u32_u24 v14, 105, v14
    v_cndmask_b32 v13, v7, 4, s[94:95]
    v_mul_u32_u24 v13, 5, v13
    v_add_u32 v13, s3, v13
    v_add_u32 v228, v12, v6
    v_add_u32 v229, 105, v228
    v_add_u32 v230, v13, v6
    v_add_u32 v230, 80, v230
    v_add_u32 v231, 105, v230
    v_add3_u32 v232, v12, v14, 4
    v_add3_u32 v233, v13, v14, 4
    v_add_u32 v233, 80, v233
    s_mul_i32 s3, s54, 7168
    s_add_u32 s3, s3, 45056
    v_mov_b32 v14, 3584

    v_and_b32 v12, 1, v228
    v_lshrrev_b32 v228, 1, v228
    v_mad_u32_u24 v12, v12, v14, s3
    v_lshl_add_u32 v228, v228, 4, v12

    v_and_b32 v12, 1, v229
    v_lshrrev_b32 v229, 1, v229
    v_mad_u32_u24 v12, v12, v14, s3
    v_lshl_add_u32 v229, v229, 4, v12

    v_and_b32 v12, 1, v230
    v_lshrrev_b32 v230, 1, v230
    v_mad_u32_u24 v12, v12, v14, s3
    v_lshl_add_u32 v230, v230, 4, v12

    v_and_b32 v12, 1, v231
    v_lshrrev_b32 v231, 1, v231
    v_mad_u32_u24 v12, v12, v14, s3
    v_lshl_add_u32 v231, v231, 4, v12

    v_and_b32 v12, 1, v232
    v_lshrrev_b32 v232, 1, v232
    v_mad_u32_u24 v12, v12, v14, s3
    v_lshl_add_u32 v232, v232, 4, v12

    v_and_b32 v12, 1, v233
    v_lshrrev_b32 v233, 1, v233
    v_mad_u32_u24 v12, v12, v14, s3
    v_lshl_add_u32 v233, v233, 4, v12

    s_cmp_eq_u32 s55, 0
    s_mov_b32 s84, 0x10f010f
    s_cselect_b32 s84, 0xf010f01, s84
    s_mov_b32 s85, 0x10f010f
    s_cselect_b32 s85, 0xf010f01, s85
    s_mov_b32 s86, 0x10f010f0
    s_cselect_b32 s86, 0xf010f010, s86
    s_mov_b32 s87, 0x10f010f0
    s_cselect_b32 s87, 0xf010f010, s87
    s_mov_b32 s88, 0x0
    s_cselect_b32 s88, 0xffff, s88
    s_mov_b32 s89, 0xffff
    s_cselect_b32 s89, 0x0, s89
    s_mov_b32 s90, 0x0
    s_cselect_b32 s90, 0xffff0000, s90
    s_mov_b32 s91, 0xffff0000
    s_cselect_b32 s91, 0x0, s91
    s_mov_b32 s92, 0x0
    s_cselect_b32 s92, 0xf0100f01, s92
    s_mov_b32 s93, 0x10f0010f
    s_cselect_b32 s93, 0x0, s93
    v_mov_b32 v235, 0x3f803f80
    v_lshlrev_b32 v241, 4, v0
    s_lshl_b32 s3, s52, 4
    s_add_u32 s48, s3, s50
    s_mul_i32 s48, s48, 4096
    s_add_u32 s48, s48, 5242880
    s_mul_i32 s44, s3, 4096
    s_add_u32 s44, s44, 5242880
    s_lshl_b32 s49, s51, 10
    s_add_u32 s44, s44, s49
    s_add_u32 s45, s44, 16384
    s_add_u32 s46, s44, 32768
    s_add_u32 s47, s44, 49152
    s_cmp_lt_u32 s51, 2
    s_mov_b32 s99, 108592
    s_cselect_b32 s99, 49152, s99
    s_add_u32 s99, s99, s49
    v_mul_u32_u24 v242, 4096, v6
    v_lshl_add_u32 v242, v5, 4, v242
    s_cmp_eq_u32 s51, 3
    s_cselect_b32 s3, 0x7fff0000, 0
    v_or_b32 v243, s3, v242
    v_lshrrev_b32 v12, 1, v5
    v_and_b32 v13, 1, v5
    v_lshlrev_b32 v13, 4, v13
    v_mov_b32 v14, 0x3f80
    v_lshlrev_b32 v13, v13, v14

    v_cmp_eq_u32 vcc, 0, v12
    s_nop 1
    v_cndmask_b32 v244, 0, v13, vcc
    v_cmp_eq_u32 vcc, 1, v12
    s_nop 1
    v_cndmask_b32 v245, 0, v13, vcc
    v_cmp_eq_u32 vcc, 2, v12
    s_nop 1
    v_cndmask_b32 v246, 0, v13, vcc
    v_cmp_eq_u32 vcc, 3, v12
    s_nop 1
    v_cndmask_b32 v247, 0, v13, vcc
    v_cmp_eq_u32 vcc, 4, v12
    s_nop 1
    v_cndmask_b32 v248, 0, v13, vcc
    v_cmp_eq_u32 vcc, 5, v12
    s_nop 1
    v_cndmask_b32 v249, 0, v13, vcc
    v_cmp_eq_u32 vcc, 6, v12
    s_nop 1
    v_cndmask_b32 v250, 0, v13, vcc
    v_cmp_eq_u32 vcc, 7, v12
    s_nop 1
    v_cndmask_b32 v251, 0, v13, vcc
    v_lshrrev_b32 v12, 1, v6
    v_lshlrev_b32 v12, 8, v12
    v_lshl_add_u32 v12, v5, 4, v12
    v_and_b32 v13, 1, v6
    v_lshl_add_u32 v12, v13, 3, v12
    s_add_u32 s3, s49, 51200
    v_add_u32 v252, s3, v12
    v_cmp_gt_u32 vcc, 210, v0
    s_mov_b64 s[100:101], vcc

    s_and_b32 s62, s2, 7
    s_lshl_b32 s62, s62, 2
    s_lshr_b32 s63, s2, 6
    s_add_u32 s62, s62, s63
    s_bfe_u32 s63, s2, 0x30003
    s_mov_b32 s36, s8
    s_mov_b32 s37, s9
    s_mov_b32 s38, 819200
    s_mov_b32 s39, 0x20000
    s_mul_i32 s3, s63, 160
    v_add_u32 v12, 0, v0
    v_mul_u32_u24 v13, 6554, v12
    v_lshrrev_b32 v13, 16, v13
    v_mul_u32_u24 v13, 1120, v13
    v_lshl_add_u32 v12, v12, 4, v13
    v_add_u32 v236, s3, v12

    v_add_u32 v12, 256, v0
    v_mul_u32_u24 v13, 6554, v12
    v_lshrrev_b32 v13, 16, v13
    v_mul_u32_u24 v13, 1120, v13
    v_lshl_add_u32 v12, v12, 4, v13
    v_add_u32 v237, s3, v12

    v_add_u32 v12, 512, v0
    v_mul_u32_u24 v13, 6554, v12
    v_lshrrev_b32 v13, 16, v13
    v_mul_u32_u24 v13, 1120, v13
    v_lshl_add_u32 v12, v12, 4, v13
    v_add_u32 v238, s3, v12

    v_add_u32 v12, 768, v0
    v_mul_u32_u24 v13, 6554, v12
    v_lshrrev_b32 v13, 16, v13
    v_mul_u32_u24 v13, 1120, v13
    v_lshl_add_u32 v12, v12, 4, v13
    v_add_u32 v239, s3, v12

    v_add_u32 v12, 1024, v0
    v_mul_u32_u24 v13, 6554, v12
    v_lshrrev_b32 v13, 16, v13
    v_mul_u32_u24 v13, 1120, v13
    v_lshl_add_u32 v12, v12, 4, v13
    v_add_u32 v240, s3, v12

    s_waitcnt lgkmcnt(0)
    s_barrier
    ds_read_b128 v[96:99], v8 offset:0
    ds_read_b64_tr_b16 v[112:113], v10 offset:0
    ds_read_b64_tr_b16 v[114:115], v10 offset:1280
    ds_read_b64_tr_b16 v[116:117], v10 offset:40
    ds_read_b64_tr_b16 v[118:119], v10 offset:1320
    ds_read_b64_tr_b16 v[120:121], v11 offset:0
    ds_read_b64_tr_b16 v[122:123], v11 offset:1280
    ds_read_b64_tr_b16 v[124:125], v10 offset:10256
    ds_read_b64_tr_b16 v[126:127], v10 offset:11536
    ds_read_b64_tr_b16 v[128:129], v10 offset:10296
    ds_read_b64_tr_b16 v[130:131], v10 offset:11576
    ds_read_b128 v[100:103], v8 offset:2048
    ds_read_b128 v[104:107], v8 offset:4096
    ds_read_b128 v[108:111], v8 offset:6144
    s_branch G_mid
G_loop:
    v_mfma_f32_16x16x32_bf16 v[16:19], v[132:135], v[148:151], v[16:19]
    ds_read_b128 v[96:99], v8 offset:0
    v_mfma_f32_16x16x32_bf16 v[20:23], v[132:135], v[152:155], v[20:23]
    ds_read_b64_tr_b16 v[112:113], v10 offset:0
    v_mfma_f32_16x16x32_bf16 v[24:27], v[132:135], v[156:159], v[24:27]
    ds_read_b64_tr_b16 v[114:115], v10 offset:1280
    v_mfma_f32_16x16x32_bf16 v[28:31], v[132:135], v[160:163], v[28:31]
    ds_read_b64_tr_b16 v[116:117], v10 offset:40
    v_mfma_f32_16x16x32_bf16 v[32:35], v[132:135], v[164:167], v[32:35]
    ds_read_b64_tr_b16 v[118:119], v10 offset:1320
    v_mfma_f32_16x16x32_bf16 v[36:39], v[136:139], v[148:151], v[36:39]
    ds_read_b64_tr_b16 v[120:121], v11 offset:0
    v_mfma_f32_16x16x32_bf16 v[40:43], v[136:139], v[152:155], v[40:43]
    ds_read_b64_tr_b16 v[122:123], v11 offset:1280
    v_mfma_f32_16x16x32_bf16 v[44:47], v[136:139], v[156:159], v[44:47]
    ds_read_b64_tr_b16 v[124:125], v10 offset:10256
    v_mfma_f32_16x16x32_bf16 v[48:51], v[136:139], v[160:163], v[48:51]
    ds_read_b64_tr_b16 v[126:127], v10 offset:11536
    v_mfma_f32_16x16x32_bf16 v[52:55], v[136:139], v[164:167], v[52:55]
    ds_read_b64_tr_b16 v[128:129], v10 offset:10296
    v_mfma_f32_16x16x32_bf16 v[56:59], v[140:143], v[148:151], v[56:59]
    ds_read_b64_tr_b16 v[130:131], v10 offset:11576
    v_mfma_f32_16x16x32_bf16 v[60:63], v[140:143], v[152:155], v[60:63]
    ds_read_b128 v[100:103], v8 offset:2048
    v_mfma_f32_16x16x32_bf16 v[64:67], v[140:143], v[156:159], v[64:67]
    ds_read_b128 v[104:107], v8 offset:4096
    v_mfma_f32_16x16x32_bf16 v[68:71], v[140:143], v[160:163], v[68:71]
    ds_read_b128 v[108:111], v8 offset:6144
    v_mfma_f32_16x16x32_bf16 v[72:75], v[140:143], v[164:167], v[72:75]
    v_mfma_f32_16x16x32_bf16 v[76:79], v[144:147], v[148:151], v[76:79]
    v_mfma_f32_16x16x32_bf16 v[80:83], v[144:147], v[152:155], v[80:83]
    v_mfma_f32_16x16x32_bf16 v[84:87], v[144:147], v[156:159], v[84:87]
    v_mfma_f32_16x16x32_bf16 v[88:91], v[144:147], v[160:163], v[88:91]
    v_mfma_f32_16x16x32_bf16 v[92:95], v[144:147], v[164:167], v[92:95]
G_mid:
    s_waitcnt lgkmcnt(0)
    s_add_u32 s57, s57, 1
    s_cmp_eq_u32 s57, 3
    s_cselect_b32 s57, 0, s57
    s_mov_b32 s59, 36880
    s_cselect_b32 s59, -73760, s59
    s_add_u32 s58, s58, 1
    s_cmp_lt_u32 s58, 10

    v_mfma_f32_16x16x32_bf16 v[16:19], v[96:99], v[112:115], v[16:19]
    ds_read_b128 v[132:135], v9 offset:0
    v_mfma_f32_16x16x32_bf16 v[20:23], v[96:99], v[116:119], v[20:23]
    ds_read_b64_tr_b16 v[148:149], v10 offset:5120
    v_mfma_f32_16x16x32_bf16 v[24:27], v[96:99], v[120:123], v[24:27]
    ds_read_b64_tr_b16 v[150:151], v10 offset:6400
    v_mfma_f32_16x16x32_bf16 v[28:31], v[96:99], v[124:127], v[28:31]
    ds_read_b64_tr_b16 v[152:153], v10 offset:5160
    v_mfma_f32_16x16x32_bf16 v[32:35], v[96:99], v[128:131], v[32:35]
    ds_read_b64_tr_b16 v[154:155], v10 offset:6440
    v_mfma_f32_16x16x32_bf16 v[36:39], v[100:103], v[112:115], v[36:39]
    ds_read_b64_tr_b16 v[156:157], v11 offset:5120
    v_mfma_f32_16x16x32_bf16 v[40:43], v[100:103], v[116:119], v[40:43]
    ds_read_b64_tr_b16 v[158:159], v11 offset:6400
    v_mfma_f32_16x16x32_bf16 v[44:47], v[100:103], v[120:123], v[44:47]
    ds_read_b64_tr_b16 v[160:161], v10 offset:15376
    v_mfma_f32_16x16x32_bf16 v[48:51], v[100:103], v[124:127], v[48:51]
    ds_read_b64_tr_b16 v[162:163], v10 offset:16656
    v_mfma_f32_16x16x32_bf16 v[52:55], v[100:103], v[128:131], v[52:55]
    ds_read_b64_tr_b16 v[164:165], v10 offset:15416
    v_mfma_f32_16x16x32_bf16 v[56:59], v[104:107], v[112:115], v[56:59]
    ds_read_b64_tr_b16 v[166:167], v10 offset:16696
    v_mfma_f32_16x16x32_bf16 v[60:63], v[104:107], v[116:119], v[60:63]
    ds_read_b128 v[136:139], v9 offset:2048
    v_mfma_f32_16x16x32_bf16 v[64:67], v[104:107], v[120:123], v[64:67]
    ds_read_b128 v[140:143], v9 offset:4096
    v_mfma_f32_16x16x32_bf16 v[68:71], v[104:107], v[124:127], v[68:71]
    ds_read_b128 v[144:147], v9 offset:6144
    v_mfma_f32_16x16x32_bf16 v[72:75], v[104:107], v[128:131], v[72:75]
    v_add_u32 v8, s59, v8
    v_mfma_f32_16x16x32_bf16 v[76:79], v[108:111], v[112:115], v[76:79]
    v_add_u32 v9, s59, v9
    v_mfma_f32_16x16x32_bf16 v[80:83], v[108:111], v[116:119], v[80:83]
    v_add_u32 v10, s59, v10
    v_mfma_f32_16x16x32_bf16 v[84:87], v[108:111], v[120:123], v[84:87]
    v_add_u32 v11, s59, v11
    v_mfma_f32_16x16x32_bf16 v[88:91], v[108:111], v[124:127], v[88:91]
    v_mfma_f32_16x16x32_bf16 v[92:95], v[108:111], v[128:131], v[92:95]
    s_waitcnt lgkmcnt(0)
    s_barrier
    s_cbranch_scc1 G_loop
    s_setprio 2
    v_mfma_f32_16x16x32_bf16 v[16:19], v[132:135], v[148:151], v[16:19]
    v_mfma_f32_16x16x32_bf16 v[20:23], v[132:135], v[152:155], v[20:23]
    v_mfma_f32_16x16x32_bf16 v[24:27], v[132:135], v[156:159], v[24:27]
    v_mfma_f32_16x16x32_bf16 v[28:31], v[132:135], v[160:163], v[28:31]
    v_mfma_f32_16x16x32_bf16 v[32:35], v[132:135], v[164:167], v[32:35]
    v_mfma_f32_16x16x32_bf16 v[36:39], v[136:139], v[148:151], v[36:39]
    v_mfma_f32_16x16x32_bf16 v[40:43], v[136:139], v[152:155], v[40:43]
    v_mfma_f32_16x16x32_bf16 v[44:47], v[136:139], v[156:159], v[44:47]
    v_mfma_f32_16x16x32_bf16 v[48:51], v[136:139], v[160:163], v[48:51]
    v_mul_f32 v216, s60, v16
    v_mul_f32 v217, s60, v17
    v_mfma_f32_16x16x32_bf16 v[52:55], v[136:139], v[164:167], v[52:55]
    v_mul_f32 v218, s60, v18
    v_mul_f32 v219, s60, v19
    v_mfma_f32_16x16x32_bf16 v[56:59], v[140:143], v[148:151], v[56:59]
    v_mul_f32 v220, s60, v20
    v_mul_f32 v221, s60, v21
    v_mfma_f32_16x16x32_bf16 v[60:63], v[140:143], v[152:155], v[60:63]
    v_mul_f32 v222, s60, v22
    v_mul_f32 v223, s60, v23
    v_mfma_f32_16x16x32_bf16 v[64:67], v[140:143], v[156:159], v[64:67]
    v_mul_f32 v224, s60, v24
    v_mul_f32 v225, s60, v25
    v_mfma_f32_16x16x32_bf16 v[68:71], v[140:143], v[160:163], v[68:71]
    v_mul_f32 v226, s60, v26
    v_mul_f32 v227, s60, v27
    v_mfma_f32_16x16x32_bf16 v[72:75], v[140:143], v[164:167], v[72:75]
    v_cvt_pk_bf16_f32 v188, v24, v25
    v_cvt_pk_bf16_f32 v189, v26, v27
    v_mfma_f32_16x16x32_bf16 v[76:79], v[144:147], v[148:151], v[76:79]
    v_exp_f32 v216, v216 clamp
    v_max_f32 v16, s61, v16
    v_mfma_f32_16x16x32_bf16 v[80:83], v[144:147], v[152:155], v[80:83]
    v_exp_f32 v217, v217 clamp
    v_max_f32 v17, s61, v17
    v_mfma_f32_16x16x32_bf16 v[84:87], v[144:147], v[156:159], v[84:87]
    v_exp_f32 v218, v218 clamp
    v_max_f32 v18, s61, v18
    v_mfma_f32_16x16x32_bf16 v[88:91], v[144:147], v[160:163], v[88:91]
    v_exp_f32 v219, v219 clamp
    v_max_f32 v19, s61, v19
    v_mfma_f32_16x16x32_bf16 v[92:95], v[144:147], v[164:167], v[92:95]
    v_exp_f32 v220, v220 clamp
    v_max_f32 v20, s61, v20
    v_exp_f32 v221, v221 clamp
    v_max_f32 v21, s61, v21
    v_exp_f32 v222, v222 clamp
    v_max_f32 v22, s61, v22
    v_exp_f32 v223, v223 clamp
    v_max_f32 v23, s61, v23
    v_cvt_pk_bf16_f32 v180, v28, v29
    v_cvt_pk_bf16_f32 v181, v30, v31
    v_cvt_pk_bf16_f32 v184, v32, v33
    v_cvt_pk_bf16_f32 v185, v34, v35
    v_exp_f32 v224, v224 clamp
    v_max_f32 v24, s61, v24
    v_exp_f32 v225, v225 clamp
    v_max_f32 v25, s61, v25
    v_exp_f32 v226, v226 clamp
    v_max_f32 v26, s61, v26
    v_exp_f32 v227, v227 clamp
    v_max_f32 v27, s61, v27
    v_add_f32 v16, v16, v216
    v_add_f32 v17, v17, v217
    v_add_f32 v18, v18, v218
    v_add_f32 v19, v19, v219
    v_add_f32 v20, v20, v220
    v_add_f32 v21, v21, v221
    v_add_f32 v22, v22, v222
    v_add_f32 v23, v23, v223
    v_add_f32 v24, v24, v224
    v_add_f32 v25, v25, v225
    v_add_f32 v26, v26, v226
    v_add_f32 v27, v27, v227
    v_cndmask_b32 v188, v188, v235, s[94:95]
    v_cndmask_b32 v189, v189, v235, s[94:95]
    v_cvt_pk_bf16_f32 v168, v16, v17
    v_cvt_pk_bf16_f32 v169, v18, v19
    v_cvt_pk_bf16_f32 v172, v20, v21
    v_cvt_pk_bf16_f32 v173, v22, v23
    v_cvt_pk_bf16_f32 v176, v24, v25
    v_cvt_pk_bf16_f32 v177, v26, v27
    v_mul_f32 v216, s60, v36
    v_mul_f32 v217, s60, v37
    v_mul_f32 v218, s60, v38
    v_mul_f32 v219, s60, v39
    v_mul_f32 v220, s60, v40
    v_mul_f32 v221, s60, v41
    v_mul_f32 v222, s60, v42
    v_mul_f32 v223, s60, v43
    v_mul_f32 v224, s60, v44
    v_mul_f32 v225, s60, v45
    v_mul_f32 v226, s60, v46
    v_mul_f32 v227, s60, v47
    v_cvt_pk_bf16_f32 v190, v44, v45
    v_cvt_pk_bf16_f32 v191, v46, v47
    v_exp_f32 v216, v216 clamp
    v_max_f32 v36, s61, v36
    v_exp_f32 v217, v217 clamp
    v_max_f32 v37, s61, v37
    v_exp_f32 v218, v218 clamp
    v_max_f32 v38, s61, v38
    v_exp_f32 v219, v219 clamp
    v_max_f32 v39, s61, v39
    v_exp_f32 v220, v220 clamp
    v_max_f32 v40, s61, v40
    v_exp_f32 v221, v221 clamp
    v_max_f32 v41, s61, v41
    v_exp_f32 v222, v222 clamp
    v_max_f32 v42, s61, v42
    v_exp_f32 v223, v223 clamp
    v_max_f32 v43, s61, v43
    v_cvt_pk_bf16_f32 v182, v48, v49
    v_cvt_pk_bf16_f32 v183, v50, v51
    v_cvt_pk_bf16_f32 v186, v52, v53
    v_cvt_pk_bf16_f32 v187, v54, v55
    v_exp_f32 v224, v224 clamp
    v_max_f32 v44, s61, v44
    v_exp_f32 v225, v225 clamp
    v_max_f32 v45, s61, v45
    v_exp_f32 v226, v226 clamp
    v_max_f32 v46, s61, v46
    v_exp_f32 v227, v227 clamp
    v_max_f32 v47, s61, v47
    v_add_f32 v36, v36, v216
    v_add_f32 v37, v37, v217
    v_add_f32 v38, v38, v218
    v_add_f32 v39, v39, v219
    v_add_f32 v40, v40, v220
    v_add_f32 v41, v41, v221
    v_add_f32 v42, v42, v222
    v_add_f32 v43, v43, v223
    v_add_f32 v44, v44, v224
    v_add_f32 v45, v45, v225
    v_add_f32 v46, v46, v226
    v_add_f32 v47, v47, v227
    v_cndmask_b32 v190, v190, v235, s[94:95]
    v_cndmask_b32 v191, v191, v235, s[94:95]
    v_cvt_pk_bf16_f32 v170, v36, v37
    v_cvt_pk_bf16_f32 v171, v38, v39
    v_cvt_pk_bf16_f32 v174, v40, v41
    v_cvt_pk_bf16_f32 v175, v42, v43
    v_cvt_pk_bf16_f32 v178, v44, v45
    v_cvt_pk_bf16_f32 v179, v46, v47
    s_barrier
    s_nop 1
    v_mfma_f32_16x16x32_bf16 v[96:99], v[168:171], v[180:183], 0
    v_mfma_f32_16x16x32_bf16 v[100:103], v[172:175], v[184:187], 0
    v_mfma_f32_16x16x32_bf16 v[104:107], v[168:171], v[188:191], 0
    v_mfma_f32_16x16x32_bf16 v[108:111], v[172:175], v[188:191], 0
    v_mfma_f32_16x16x32_bf16 v[112:115], v[176:179], v[180:183], 0
    v_mfma_f32_16x16x32_bf16 v[116:119], v[176:179], v[184:187], 0
    v_mfma_f32_16x16x32_bf16 v[120:123], v[176:179], v[188:191], 0
    v_mul_f32 v216, s60, v56
    v_mul_f32 v217, s60, v57
    v_mul_f32 v218, s60, v58
    v_mul_f32 v219, s60, v59
    v_mul_f32 v220, s60, v60
    v_mul_f32 v221, s60, v61
    v_mul_f32 v222, s60, v62
    v_mul_f32 v223, s60, v63
    v_mul_f32 v224, s60, v64
    v_mul_f32 v225, s60, v65
    v_mul_f32 v226, s60, v66
    v_mul_f32 v227, s60, v67
    v_cvt_pk_bf16_f32 v212, v64, v65
    v_cvt_pk_bf16_f32 v213, v66, v67
    v_exp_f32 v216, v216 clamp
    v_max_f32 v56, s61, v56
    v_exp_f32 v217, v217 clamp
    v_max_f32 v57, s61, v57
    v_exp_f32 v218, v218 clamp
    v_max_f32 v58, s61, v58
    v_exp_f32 v219, v219 clamp
    v_max_f32 v59, s61, v59
    v_exp_f32 v220, v220 clamp
    v_max_f32 v60, s61, v60
    v_exp_f32 v221, v221 clamp
    v_max_f32 v61, s61, v61
    v_exp_f32 v222, v222 clamp
    v_max_f32 v62, s61, v62
    v_exp_f32 v223, v223 clamp
    v_max_f32 v63, s61, v63
    v_cvt_pk_bf16_f32 v204, v68, v69
    v_cvt_pk_bf16_f32 v205, v70, v71
    v_cvt_pk_bf16_f32 v208, v72, v73
    v_cvt_pk_bf16_f32 v209, v74, v75
    v_exp_f32 v224, v224 clamp
    v_max_f32 v64, s61, v64
    v_exp_f32 v225, v225 clamp
    v_max_f32 v65, s61, v65
    v_exp_f32 v226, v226 clamp
    v_max_f32 v66, s61, v66
    v_exp_f32 v227, v227 clamp
    v_max_f32 v67, s61, v67
    v_add_f32 v56, v56, v216
    v_add_f32 v57, v57, v217
    v_add_f32 v58, v58, v218
    v_add_f32 v59, v59, v219
    v_add_f32 v60, v60, v220
    v_add_f32 v61, v61, v221
    v_add_f32 v62, v62, v222
    v_add_f32 v63, v63, v223
    v_add_f32 v64, v64, v224
    v_add_f32 v65, v65, v225
    v_add_f32 v66, v66, v226
    v_add_f32 v67, v67, v227
    v_cndmask_b32 v212, v212, v235, s[94:95]
    v_cndmask_b32 v213, v213, v235, s[94:95]
    v_cvt_pk_bf16_f32 v192, v56, v57
    v_cvt_pk_bf16_f32 v193, v58, v59
    v_cvt_pk_bf16_f32 v196, v60, v61
    v_cvt_pk_bf16_f32 v197, v62, v63
    v_cvt_pk_bf16_f32 v200, v64, v65
    v_cvt_pk_bf16_f32 v201, v66, v67
    v_mul_f32 v216, s60, v76
    v_mul_f32 v217, s60, v77
    v_mul_f32 v218, s60, v78
    v_mul_f32 v219, s60, v79
    v_mul_f32 v220, s60, v80
    v_mul_f32 v221, s60, v81
    v_mul_f32 v222, s60, v82
    v_mul_f32 v223, s60, v83
    v_mul_f32 v224, s60, v84
    v_mul_f32 v225, s60, v85
    v_mul_f32 v226, s60, v86
    v_mul_f32 v227, s60, v87
    v_cvt_pk_bf16_f32 v214, v84, v85
    v_cvt_pk_bf16_f32 v215, v86, v87
    v_exp_f32 v216, v216 clamp
    v_max_f32 v76, s61, v76
    v_exp_f32 v217, v217 clamp
    v_max_f32 v77, s61, v77
    v_exp_f32 v218, v218 clamp
    v_max_f32 v78, s61, v78
    v_exp_f32 v219, v219 clamp
    v_max_f32 v79, s61, v79
    v_exp_f32 v220, v220 clamp
    v_max_f32 v80, s61, v80
    v_exp_f32 v221, v221 clamp
    v_max_f32 v81, s61, v81
    v_exp_f32 v222, v222 clamp
    v_max_f32 v82, s61, v82
    v_exp_f32 v223, v223 clamp
    v_max_f32 v83, s61, v83
    v_cvt_pk_bf16_f32 v206, v88, v89
    v_cvt_pk_bf16_f32 v207, v90, v91
    v_cvt_pk_bf16_f32 v210, v92, v93
    v_cvt_pk_bf16_f32 v211, v94, v95
    v_exp_f32 v224, v224 clamp
    v_max_f32 v84, s61, v84
    v_exp_f32 v225, v225 clamp
    v_max_f32 v85, s61, v85
    v_exp_f32 v226, v226 clamp
    v_max_f32 v86, s61, v86
    v_exp_f32 v227, v227 clamp
    v_max_f32 v87, s61, v87
    v_add_f32 v76, v76, v216
    v_add_f32 v77, v77, v217
    v_add_f32 v78, v78, v218
    v_add_f32 v79, v79, v219
    v_add_f32 v80, v80, v220
    v_add_f32 v81, v81, v221
    v_add_f32 v82, v82, v222
    v_add_f32 v83, v83, v223
    v_add_f32 v84, v84, v224
    v_add_f32 v85, v85, v225
    v_add_f32 v86, v86, v226
    v_add_f32 v87, v87, v227
    v_cndmask_b32 v214, v214, v235, s[94:95]
    v_cndmask_b32 v215, v215, v235, s[94:95]
    v_cvt_pk_bf16_f32 v194, v76, v77
    v_cvt_pk_bf16_f32 v195, v78, v79
    v_cvt_pk_bf16_f32 v198, v80, v81
    v_cvt_pk_bf16_f32 v199, v82, v83
    v_cvt_pk_bf16_f32 v202, v84, v85
    v_cvt_pk_bf16_f32 v203, v86, v87
    s_nop 1
    v_mfma_f32_16x16x32_bf16 v[96:99], v[192:195], v[204:207], v[96:99]
    v_mfma_f32_16x16x32_bf16 v[100:103], v[196:199], v[208:211], v[100:103]
    v_mfma_f32_16x16x32_bf16 v[104:107], v[192:195], v[212:215], v[104:107]
    v_mfma_f32_16x16x32_bf16 v[108:111], v[196:199], v[212:215], v[108:111]
    v_mfma_f32_16x16x32_bf16 v[112:115], v[200:203], v[204:207], v[112:115]
    v_mfma_f32_16x16x32_bf16 v[116:119], v[200:203], v[208:211], v[116:119]
    v_mfma_f32_16x16x32_bf16 v[120:123], v[200:203], v[212:215], v[120:123]
    s_nop 3
    ds_write_b128 v228, v[96:99]
    ds_write_b128 v229, v[100:103]
    s_mov_b64 exec, s[84:85]
    ds_write_b128 v230, v[104:107]
    s_mov_b64 exec, s[86:87]
    ds_write_b128 v231, v[108:111]
    s_mov_b64 exec, s[88:89]
    ds_write_b128 v232, v[112:115]
    s_mov_b64 exec, s[90:91]
    ds_write_b128 v232, v[116:119]
    s_mov_b64 exec, s[92:93]
    ds_write_b128 v233, v[120:123]
    s_mov_b64 exec, -1
    s_waitcnt lgkmcnt(0)
    s_barrier

    ds_read_b128 v[16:19], v241 offset:45056
    ds_read_b128 v[24:27], v241 offset:52224
    ds_read_b128 v[20:23], v241 offset:48640
    ds_read_b128 v[28:31], v241 offset:55808
    s_waitcnt lgkmcnt(2)

    v_add_f32 v16, v16, v24
    v_add_f32 v17, v17, v25
    v_add_f32 v18, v18, v26
    v_add_f32 v19, v19, v27
    s_waitcnt lgkmcnt(0)
    v_add_f32 v20, v20, v28
    v_add_f32 v21, v21, v29
    v_add_f32 v22, v22, v30
    v_add_f32 v23, v23, v31
    v_cvt_pk_bf16_f32 v32, v16, v17
    v_cvt_pk_bf16_f32 v33, v18, v19
    v_cvt_pk_bf16_f32 v34, v20, v21
    v_cvt_pk_bf16_f32 v35, v22, v23
    v_cndmask_b32 v32, 0, v32, s[100:101]
    v_cndmask_b32 v33, 0, v33, s[100:101]
    v_cndmask_b32 v34, 0, v34, s[100:101]
    v_cndmask_b32 v35, 0, v35, s[100:101]
    buffer_store_dwordx4 v[32:35], v241, s[40:43], s48 offen sc1
    s_setprio 0
    v_mov_b32 v16, 0
    v_mov_b32 v17, 0
    v_mov_b32 v18, 0
    v_mov_b32 v19, 0
    v_mov_b32 v20, 0
    v_mov_b32 v21, 0
    v_mov_b32 v22, 0
    v_mov_b32 v23, 0
    s_barrier
    s_add_u32 m0, s49, 45056
    s_mov_b32 s98, 327680
    buffer_load_dwordx4 v237, s[36:39], s98 offen lds
    s_mov_b32 m0, s99
    s_mov_b32 s98, 327680
    buffer_load_dwordx4 v238, s[36:39], s98 offen lds
    s_add_u32 m0, s49, 112688
    s_mov_b32 s98, 327680
    buffer_load_dwordx4 v239, s[36:39], s98 offen lds
    s_add_u32 m0, s49, 116784
    s_mov_b32 s98, 327680
    buffer_load_dwordx4 v240, s[36:39], s98 offen lds
    s_add_u32 m0, s49, 120880
    s_mov_b32 s98, 491520
    buffer_load_dwordx4 v236, s[36:39], s98 offen lds
    s_add_u32 m0, s49, 124976
    s_mov_b32 s98, 491520
    buffer_load_dwordx4 v237, s[36:39], s98 offen lds
    s_add_u32 m0, s49, 129072
    s_mov_b32 s98, 491520
    buffer_load_dwordx4 v238, s[36:39], s98 offen lds
    s_add_u32 m0, s49, 133168
    s_mov_b32 s98, 491520
    buffer_load_dwordx4 v239, s[36:39], s98 offen lds
    s_add_u32 m0, s49, 137264
    s_mov_b32 s98, 491520
    buffer_load_dwordx4 v240, s[36:39], s98 offen lds
    s_add_u32 m0, s49, 141360
    s_mov_b32 s98, 655360
    buffer_load_dwordx4 v236, s[36:39], s98 offen lds
    buffer_load_dwordx4 v[48:51], v242, s[40:43], s44 offen offset:0 sc1
    buffer_load_dwordx4 v[52:55], v242, s[40:43], s44 offen offset:256 sc1
    buffer_load_dwordx4 v[56:59], v243, s[40:43], s44 offen offset:512 sc1
    buffer_load_dwordx4 v[60:63], v243, s[40:43], s44 offen offset:768 sc1
    buffer_load_dwordx4 v[64:67], v242, s[40:43], s45 offen offset:0 sc1
    buffer_load_dwordx4 v[68:71], v242, s[40:43], s45 offen offset:256 sc1
    buffer_load_dwordx4 v[72:75], v243, s[40:43], s45 offen offset:512 sc1
    buffer_load_dwordx4 v[76:79], v243, s[40:43], s45 offen offset:768 sc1
    buffer_load_dwordx4 v[80:83], v242, s[40:43], s46 offen offset:0 sc1
    buffer_load_dwordx4 v[84:87], v242, s[40:43], s46 offen offset:256 sc1
    buffer_load_dwordx4 v[88:91], v243, s[40:43], s46 offen offset:512 sc1
    buffer_load_dwordx4 v[92:95], v243, s[40:43], s46 offen offset:768 sc1
    buffer_load_dwordx4 v[96:99], v242, s[40:43], s47 offen offset:0 sc1
    buffer_load_dwordx4 v[100:103], v242, s[40:43], s47 offen offset:256 sc1
    buffer_load_dwordx4 v[104:107], v243, s[40:43], s47 offen offset:512 sc1
    buffer_load_dwordx4 v[108:111], v243, s[40:43], s47 offen offset:768 sc1
    s_add_u32 m0, s49, 145456
    s_mov_b32 s98, 655360
    buffer_load_dwordx4 v237, s[36:39], s98 offen lds
    s_add_u32 m0, s49, 149552
    s_mov_b32 s98, 655360
    buffer_load_dwordx4 v238, s[36:39], s98 offen lds
    s_add_u32 m0, s49, 153648
    s_mov_b32 s98, 655360
    buffer_load_dwordx4 v239, s[36:39], s98 offen lds
    s_add_u32 m0, s49, 157744
    s_mov_b32 s98, 655360
    buffer_load_dwordx4 v240, s[36:39], s98 offen lds
    s_mov_b32 s56, 15
    s_mov_b32 s58, 0
    s_mov_b64 s[96:97], -1
G_poll:
    s_bitcmp1_b32 s56, 0
    s_cbranch_scc0 G_n0
    s_waitcnt vmcnt(16)
    v_max3_u32 v2, v48, v52, v56
    v_max_u32 v2, v2, v60
    v_cmp_eq_u32 vcc, -1, v2
    s_and_b64 vcc, vcc, s[96:97]
    s_cbranch_scc1 G_n0
    s_bitset0_b32 s56, 0

    v_mfma_f32_16x16x32_bf16 v[16:19], v[244:247], v[48:51], v[16:19]
    v_mfma_f32_16x16x32_bf16 v[16:19], v[248:251], v[52:55], v[16:19]
    v_mfma_f32_16x16x32_bf16 v[20:23], v[244:247], v[56:59], v[20:23]
    v_mfma_f32_16x16x32_bf16 v[20:23], v[248:251], v[60:63], v[20:23]
G_n0:
    s_bitcmp1_b32 s56, 1
    s_cbranch_scc0 G_n1
    s_waitcnt vmcnt(12)
    v_max3_u32 v2, v64, v68, v72
    v_max_u32 v2, v2, v76
    v_cmp_eq_u32 vcc, -1, v2
    s_and_b64 vcc, vcc, s[96:97]
    s_cbranch_scc1 G_n1
    s_bitset0_b32 s56, 1

    v_mfma_f32_16x16x32_bf16 v[16:19], v[244:247], v[64:67], v[16:19]
    v_mfma_f32_16x16x32_bf16 v[16:19], v[248:251], v[68:71], v[16:19]
    v_mfma_f32_16x16x32_bf16 v[20:23], v[244:247], v[72:75], v[20:23]
    v_mfma_f32_16x16x32_bf16 v[20:23], v[248:251], v[76:79], v[20:23]
G_n1:
    s_bitcmp1_b32 s56, 2
    s_cbranch_scc0 G_n2
    s_waitcnt vmcnt(8)
    v_max3_u32 v2, v80, v84, v88
    v_max_u32 v2, v2, v92
    v_cmp_eq_u32 vcc, -1, v2
    s_and_b64 vcc, vcc, s[96:97]
    s_cbranch_scc1 G_n2
    s_bitset0_b32 s56, 2

    v_mfma_f32_16x16x32_bf16 v[16:19], v[244:247], v[80:83], v[16:19]
    v_mfma_f32_16x16x32_bf16 v[16:19], v[248:251], v[84:87], v[16:19]
    v_mfma_f32_16x16x32_bf16 v[20:23], v[244:247], v[88:91], v[20:23]
    v_mfma_f32_16x16x32_bf16 v[20:23], v[248:251], v[92:95], v[20:23]
G_n2:
    s_bitcmp1_b32 s56, 3
    s_cbranch_scc0 G_n3
    s_waitcnt vmcnt(4)
    v_max3_u32 v2, v96, v100, v104
    v_max_u32 v2, v2, v108
    v_cmp_eq_u32 vcc, -1, v2
    s_and_b64 vcc, vcc, s[96:97]
    s_cbranch_scc1 G_n3
    s_bitset0_b32 s56, 3

    v_mfma_f32_16x16x32_bf16 v[16:19], v[244:247], v[96:99], v[16:19]
    v_mfma_f32_16x16x32_bf16 v[16:19], v[248:251], v[100:103], v[16:19]
    v_mfma_f32_16x16x32_bf16 v[20:23], v[244:247], v[104:107], v[20:23]
    v_mfma_f32_16x16x32_bf16 v[20:23], v[248:251], v[108:111], v[20:23]
G_n3:
    s_cmp_eq_u32 s56, 0
    s_cbranch_scc1 G_done
    s_bitcmp1_b32 s56, 0
    s_cbranch_scc0 G_r0
    buffer_load_dwordx4 v[48:51], v242, s[40:43], s44 offen offset:0 sc1
    buffer_load_dwordx4 v[52:55], v242, s[40:43], s44 offen offset:256 sc1
    buffer_load_dwordx4 v[56:59], v243, s[40:43], s44 offen offset:512 sc1
    buffer_load_dwordx4 v[60:63], v243, s[40:43], s44 offen offset:768 sc1
G_r0:
    s_bitcmp1_b32 s56, 1
    s_cbranch_scc0 G_r1
    buffer_load_dwordx4 v[64:67], v242, s[40:43], s45 offen offset:0 sc1
    buffer_load_dwordx4 v[68:71], v242, s[40:43], s45 offen offset:256 sc1
    buffer_load_dwordx4 v[72:75], v243, s[40:43], s45 offen offset:512 sc1
    buffer_load_dwordx4 v[76:79], v243, s[40:43], s45 offen offset:768 sc1
G_r1:
    s_bitcmp1_b32 s56, 2
    s_cbranch_scc0 G_r2
    buffer_load_dwordx4 v[80:83], v242, s[40:43], s46 offen offset:0 sc1
    buffer_load_dwordx4 v[84:87], v242, s[40:43], s46 offen offset:256 sc1
    buffer_load_dwordx4 v[88:91], v243, s[40:43], s46 offen offset:512 sc1
    buffer_load_dwordx4 v[92:95], v243, s[40:43], s46 offen offset:768 sc1
G_r2:
    s_bitcmp1_b32 s56, 3
    s_cbranch_scc0 G_r3
    buffer_load_dwordx4 v[96:99], v242, s[40:43], s47 offen offset:0 sc1
    buffer_load_dwordx4 v[100:103], v242, s[40:43], s47 offen offset:256 sc1
    buffer_load_dwordx4 v[104:107], v243, s[40:43], s47 offen offset:512 sc1
    buffer_load_dwordx4 v[108:111], v243, s[40:43], s47 offen offset:768 sc1
G_r3:
    s_add_u32 s58, s58, 1
    s_cmp_lt_u32 s58, 16384
    s_cselect_b64 s[96:97], -1, 0
    s_waitcnt vmcnt(0)
    s_branch G_poll
G_done:
    s_nop 2
    s_mov_b32 s58, 110640
    s_mov_b32 s59, 59648
    s_nop 1

    v_cvt_pk_bf16_f32 v16, v16, v17
    v_cvt_pk_bf16_f32 v17, v18, v19
    ds_write_b64 v252, v[16:17] offset:0
    v_cvt_pk_bf16_f32 v20, v20, v21
    v_cvt_pk_bf16_f32 v21, v22, v23
    ds_write_b64 v252, v[20:21] offset:512
    s_waitcnt lgkmcnt(0)
    s_barrier
    s_branch FIN
K_ssm:
    s_sub_u32 s3, s2, 128
    s_and_b32 s50, s3, 7
    s_lshr_b32 s3, s3, 3
    s_mul_i32 s50, s50, 10
    s_add_u32 s50, s50, s3

    s_lshl_b32 s52, s50, 3
    s_add_u32 s52, s52, s51
    s_lshl_b32 s53, s52, 8
    v_lshl_add_u32 v2, v1, 2, s53
    s_lshl_b32 s54, s52, 1
    s_and_b32 s55, s54, 0xfffffffc
    s_load_dword s56, s[20:21], s55
    s_load_dword s57, s[22:23], s55
    global_load_dword v28, v2, s[12:13]
    global_load_dword v29, v2, s[14:15]
    global_load_dword v30, v2, s[16:17]
    global_load_dword v31, v2, s[18:19]
    s_and_b32 s58, s50, 7
    s_lshl_b32 s58, s58, 8
    v_lshl_add_u32 v3, v0, 2, s58
    v_and_b32 v3, 2047, v3
    v_mul_u32_u24 v251, 1280, v3
    v_bfe_u32 v250, v1, 1, 2
    v_or_b32 v250, v250, v3
    s_and_b32 s58, s50, 3
    v_xor_b32 v250, s58, v250
    s_lshl_b32 s59, s50, 4
    s_lshl_b32 s97, s50, 7
    s_add_u32 s97, s97, 5767168

    s_lshr_b32 s47, s2, 3
    s_lshl_b32 s3, s64, 4
    s_add_u32 s47, s47, s3
    s_sub_u32 s47, s47, 16
    s_cmp_ge_u32 s47, 108
    s_cbranch_scc1 L_pf_2q
    s_mul_i32 s44, s47, 3641
    s_lshr_b32 s44, s44, 16
    s_mul_i32 s45, s44, 18
    s_sub_u32 s45, s47, s45
    s_lshl_b32 s44, s44, 2
    s_lshr_b32 s44, 0x948631, s44
    s_and_b32 s44, s44, 15
    s_cmp_ge_u32 s45, 8
    s_cbranch_scc1 L_pf_2w
    s_and_b32 s46, s2, 3
    s_lshl_b32 s46, s46, 3
    s_add_u32 s46, s46, s45
    s_mul_i32 s46, s46, 81920
    s_lshl_b32 s44, s44, 7
    s_add_u32 s46, s46, s44
    v_mul_u32_u24 v254, 1280, v1
    buffer_load_dword v254, v254, s[32:35], s46 offen
    s_branch L_pf_2x
L_pf_2q:
    s_sub_u32 s45, s47, 108
    s_mul_i32 s44, s45, 13108
    s_lshr_b32 s44, s44, 16
    s_mul_i32 s46, s44, 5
    s_sub_u32 s45, s45, s46
    s_branch L_pf_2v
L_pf_2w:
    s_cmp_ge_u32 s45, 13
    s_cselect_b32 s46, 7, 2
    s_add_u32 s45, s45, s46
L_pf_2v:
    s_mul_i32 s44, s44, 245760
    s_lshl_b32 s45, s45, 7
    s_add_u32 s44, s44, s45
    s_bfe_u32 s45, s2, 0x10002
    s_mul_i32 s45, s45, 640
    s_add_u32 s44, s44, s45
    v_mul_u32_u24 v254, 3840, v1
    v_add_u32 v254, s44, v254
    global_load_dword v254, v254, s[6:7]
L_pf_2x:

    v_lshlrev_b32 v3, 1, v3
    v_add_u32 v3, 127488, v3
    v_and_b32 v5, 15, v1
    v_lshrrev_b32 v6, 4, v1
    s_mul_i32 s60, s51, 4608
    s_add_u32 s60, s60, 126976
    v_mov_b32 v8, 0
    v_mov_b32 v9, 0
    v_mov_b32 v10, 0
    v_mov_b32 v11, 0
    v_lshl_add_u32 v7, v1, 3, s60
    ds_write_b64 v7, v[8:9]
    s_lshl_b32 s61, s51, 10
    s_add_u32 s61, s61, 115584
    v_lshl_add_u32 v7, v1, 2, s61
    v_mov_b32 v50, 0x3f80
    v_mov_b32 v51, 0x3f800000

    v_subrev_u32 v48, 31, v1
    v_subrev_u32 v49, 32, v1
    v_cmp_ge_u32 vcc, 2, v48
    v_cmp_ge_u32 s[62:63], 2, v49
    s_nop 0
    v_cndmask_b32 v48, 0, v50, vcc
    v_cndmask_b32 v49, 0, v51, s[62:63]
    v_or_b32 v52, v48, v49
    ds_write_b32 v7, v52 offset:0

    v_subrev_u32 v48, 30, v1
    v_subrev_u32 v49, 31, v1
    v_cmp_ge_u32 vcc, 4, v48
    v_cmp_ge_u32 s[62:63], 4, v49
    s_nop 0
    v_cndmask_b32 v48, 0, v50, vcc
    v_cndmask_b32 v49, 0, v51, s[62:63]
    v_or_b32 v53, v48, v49
    ds_write_b32 v7, v53 offset:256

    v_subrev_u32 v48, 29, v1
    v_subrev_u32 v49, 30, v1
    v_cmp_ge_u32 vcc, 6, v48
    v_cmp_ge_u32 s[62:63], 6, v49
    s_nop 0
    v_cndmask_b32 v48, 0, v50, vcc
    v_cndmask_b32 v49, 0, v51, s[62:63]
    v_or_b32 v54, v48, v49
    ds_write_b32 v7, v54 offset:512

    v_subrev_u32 v48, 28, v1
    v_subrev_u32 v49, 29, v1
    v_cmp_ge_u32 vcc, 8, v48
    v_cmp_ge_u32 s[62:63], 8, v49
    s_nop 0
    v_cndmask_b32 v48, 0, v50, vcc
    v_cndmask_b32 v49, 0, v51, s[62:63]
    v_or_b32 v55, v48, v49
    ds_write_b32 v7, v55 offset:768

    v_lshlrev_b32 v2, 3, v6
    v_sub_u32 v2, v5, v2
    v_add_u32 v2, 24, v2
    v_lshlrev_b32 v2, 2, v2
    v_add_u32 v7, s61, v2

    ds_read2_b32 v[32:33], v7 offset0:20 offset1:18
    ds_read2_b32 v[34:35], v7 offset0:16 offset1:14
    ds_read2_b32 v[36:37], v7 offset0:80 offset1:78
    ds_read2_b32 v[38:39], v7 offset0:76 offset1:74
    ds_read2_b32 v[40:41], v7 offset0:144 offset1:142
    ds_read2_b32 v[42:43], v7 offset0:140 offset1:138
    ds_read2_b32 v[44:45], v7 offset0:208 offset1:206
    ds_read2_b32 v[46:47], v7 offset0:204 offset1:202
    v_and_b32 v48, 31, v1
    v_lshrrev_b32 v49, 5, v1
    v_mul_u32_u24 v4, 2064, v48
    s_lshl_b32 s53, s51, 8
    v_lshl_add_u32 v4, v49, 4, v4
    v_add_u32 v4, s53, v4
    s_waitcnt lgkmcnt(0)
    s_and_b32 s54, s54, 2
    s_lshl_b32 s54, s54, 3
    s_lshr_b32 s56, s56, s54
    s_lshl_b32 s56, s56, 16
    s_lshr_b32 s57, s57, s54
    s_lshl_b32 s57, s57, 16
    v_mov_b32 v60, 0x3fb8aa3b
    v_mul_f32 v61, s56, v60
    v_exp_f32 v61, v61
    s_nop 0
    v_cvt_pk_bf16_f32 v61, v61, v61
    v_and_b32 v61, 0xffff0000, v61
    v_mul_f32 v62, v61, v60
    v_mul_f32 v63, 0.15915494, v61
    v_add_f32 v61, v61, v61

    s_waitcnt vmcnt(1)
    s_setprio 3
    v_lshlrev_b32 v48, 16, v28
    v_lshlrev_b32 v49, 16, v29
    v_lshlrev_b32 v50, 16, v30
    v_lshlrev_b32 v51, 16, v31
    v_mul_f32 v48, v48, v60
    v_exp_f32 v48, v48
    v_mul_f32 v49, v49, v63
    v_mul_f32 v70, v50, v61
    v_mul_f32 v71, v51, -v61
    v_cvt_pk_bf16_f32 v48, v48, v48
    v_and_b32 v48, 0xffff0000, v48
    v_mul_f32 v48, v48, -v62
    v_mul_f32 v50, 0x41000000, v49
    v_mul_f32 v51, 0x43800000, v49
    v_mul_f32 v52, 0x41000000, v48
    v_mul_f32 v53, 0x43800000, v48
    v_fract_f32 v49, v49
    v_fract_f32 v50, v50
    v_fract_f32 v51, v51
    v_exp_f32 v48, v48
    v_exp_f32 v52, v52
    v_exp_f32 v53, v53
    v_cos_f32 v64, v49
    v_sin_f32 v65, v49
    v_cos_f32 v66, v50
    v_sin_f32 v67, v50
    v_cos_f32 v68, v51
    v_sin_f32 v69, v51
    s_mov_b32 m0, s53
    v_mul_f32 v64, v64, v48
    v_mul_f32 v65, v65, -v48
    v_mul_f32 v66, v66, v52
    v_mul_f32 v67, v67, v52
    v_mul_f32 v68, v68, v53
    v_mul_f32 v69, v69, -v53

    v_pk_mul_f32 v[122:123], v[70:71], v[64:65] op_sel:[0,0] op_sel_hi:[0,1]
    v_pk_mul_f32 v[124:125], v[64:65], v[64:65] op_sel:[0,0] op_sel_hi:[0,1]
    v_pk_mul_f32 v[126:127], v[68:69], v[68:69] op_sel:[0,0] op_sel_hi:[0,1]
    v_pk_fma_f32 v[72:73], v[70:71], v[64:65], v[122:123] op_sel:[1,1,0] op_sel_hi:[1,0,1] neg_lo:[1,0,0]
    v_pk_fma_f32 v[118:119], v[64:65], v[64:65], v[124:125] op_sel:[1,1,0] op_sel_hi:[1,0,1] neg_lo:[1,0,0]
    v_pk_fma_f32 v[120:121], v[68:69], v[68:69], v[126:127] op_sel:[1,1,0] op_sel_hi:[1,0,1] neg_lo:[1,0,0]
    v_cvt_pk_bf16_f32 v56, v70, v71
    ds_write_addtid_b32 v56 offset:0
    v_pk_mul_f32 v[122:123], v[70:71], v[118:119] op_sel:[0,0] op_sel_hi:[0,1]
    v_pk_mul_f32 v[124:125], v[72:73], v[118:119] op_sel:[0,0] op_sel_hi:[0,1]
    v_pk_mul_f32 v[126:127], v[70:71], v[68:69] op_sel:[0,0] op_sel_hi:[0,1]
    v_pk_fma_f32 v[74:75], v[70:71], v[118:119], v[122:123] op_sel:[1,1,0] op_sel_hi:[1,0,1] neg_lo:[1,0,0]
    v_pk_fma_f32 v[76:77], v[72:73], v[118:119], v[124:125] op_sel:[1,1,0] op_sel_hi:[1,0,1] neg_lo:[1,0,0]
    v_pk_fma_f32 v[78:79], v[70:71], v[68:69], v[126:127] op_sel:[1,1,0] op_sel_hi:[1,0,1] neg_lo:[1,0,0]
    v_cvt_pk_bf16_f32 v57, v72, v73
    ds_write_addtid_b32 v57 offset:2064
    v_cvt_pk_bf16_f32 v58, v74, v75
    ds_write_addtid_b32 v58 offset:4128
    v_cvt_pk_bf16_f32 v59, v78, v79
    ds_write_addtid_b32 v59 offset:18576
    v_pk_mul_f32 v[122:123], v[74:75], v[118:119] op_sel:[0,0] op_sel_hi:[0,1]
    v_pk_mul_f32 v[124:125], v[76:77], v[118:119] op_sel:[0,0] op_sel_hi:[0,1]
    v_pk_mul_f32 v[126:127], v[74:75], v[68:69] op_sel:[0,0] op_sel_hi:[0,1]
    v_pk_fma_f32 v[80:81], v[74:75], v[118:119], v[122:123] op_sel:[1,1,0] op_sel_hi:[1,0,1] neg_lo:[1,0,0]
    v_pk_fma_f32 v[82:83], v[76:77], v[118:119], v[124:125] op_sel:[1,1,0] op_sel_hi:[1,0,1] neg_lo:[1,0,0]
    v_pk_fma_f32 v[84:85], v[74:75], v[68:69], v[126:127] op_sel:[1,1,0] op_sel_hi:[1,0,1] neg_lo:[1,0,0]
    v_cvt_pk_bf16_f32 v56, v76, v77
    ds_write_addtid_b32 v56 offset:6192
    v_cvt_pk_bf16_f32 v57, v80, v81
    ds_write_addtid_b32 v57 offset:8256
    ds_write_addtid_b32 v57 offset:16512
    v_cvt_pk_bf16_f32 v58, v84, v85
    ds_write_addtid_b32 v58 offset:20640
    v_pk_mul_f32 v[122:123], v[80:81], v[118:119] op_sel:[0,0] op_sel_hi:[0,1]
    v_pk_mul_f32 v[124:125], v[82:83], v[118:119] op_sel:[0,0] op_sel_hi:[0,1]
    v_pk_mul_f32 v[126:127], v[80:81], v[68:69] op_sel:[0,0] op_sel_hi:[0,1]
    v_pk_fma_f32 v[86:87], v[80:81], v[118:119], v[122:123] op_sel:[1,1,0] op_sel_hi:[1,0,1] neg_lo:[1,0,0]
    v_pk_fma_f32 v[88:89], v[82:83], v[118:119], v[124:125] op_sel:[1,1,0] op_sel_hi:[1,0,1] neg_lo:[1,0,0]
    v_pk_fma_f32 v[90:91], v[80:81], v[68:69], v[126:127] op_sel:[1,1,0] op_sel_hi:[1,0,1] neg_lo:[1,0,0]
    v_cvt_pk_bf16_f32 v59, v82, v83
    ds_write_addtid_b32 v59 offset:10320
    v_cvt_pk_bf16_f32 v56, v86, v87
    ds_write_addtid_b32 v56 offset:12384
    v_cvt_pk_bf16_f32 v57, v90, v91
    ds_write_addtid_b32 v57 offset:22704
    ds_write_addtid_b32 v57 offset:26832
    v_pk_mul_f32 v[122:123], v[86:87], v[118:119] op_sel:[0,0] op_sel_hi:[0,1]
    v_pk_mul_f32 v[124:125], v[86:87], v[68:69] op_sel:[0,0] op_sel_hi:[0,1]
    v_pk_mul_f32 v[126:127], v[80:81], v[120:121] op_sel:[0,0] op_sel_hi:[0,1]
    v_pk_fma_f32 v[92:93], v[86:87], v[118:119], v[122:123] op_sel:[1,1,0] op_sel_hi:[1,0,1] neg_lo:[1,0,0]
    v_pk_fma_f32 v[94:95], v[86:87], v[68:69], v[124:125] op_sel:[1,1,0] op_sel_hi:[1,0,1] neg_lo:[1,0,0]
    v_pk_fma_f32 v[96:97], v[80:81], v[120:121], v[126:127] op_sel:[1,1,0] op_sel_hi:[1,0,1] neg_lo:[1,0,0]
    v_cvt_pk_bf16_f32 v58, v88, v89
    ds_write_addtid_b32 v58 offset:14448
    v_pk_mul_f32 v[122:123], v[92:93], v[68:69] op_sel:[0,0] op_sel_hi:[0,1]
    v_pk_mul_f32 v[124:125], v[92:93], v[120:121] op_sel:[0,0] op_sel_hi:[0,1]
    v_pk_mul_f32 v[126:127], v[90:91], v[120:121] op_sel:[0,0] op_sel_hi:[0,1]
    v_pk_fma_f32 v[98:99], v[92:93], v[68:69], v[122:123] op_sel:[1,1,0] op_sel_hi:[1,0,1] neg_lo:[1,0,0]
    v_pk_fma_f32 v[100:101], v[92:93], v[120:121], v[124:125] op_sel:[1,1,0] op_sel_hi:[1,0,1] neg_lo:[1,0,0]
    v_pk_fma_f32 v[102:103], v[90:91], v[120:121], v[126:127] op_sel:[1,1,0] op_sel_hi:[1,0,1] neg_lo:[1,0,0]
    v_cvt_pk_bf16_f32 v59, v92, v93
    ds_write_addtid_b32 v59 offset:24768
    v_cvt_pk_bf16_f32 v56, v94, v95
    ds_write_addtid_b32 v56 offset:28896
    v_cvt_pk_bf16_f32 v57, v96, v97
    ds_write_addtid_b32 v57 offset:33024
    v_pk_mul_f32 v[122:123], v[98:99], v[120:121] op_sel:[0,0] op_sel_hi:[0,1]
    v_pk_mul_f32 v[124:125], v[100:101], v[120:121] op_sel:[0,0] op_sel_hi:[0,1]
    v_pk_mul_f32 v[126:127], v[66:67], v[66:67] op_sel:[0,0] op_sel_hi:[0,1]
    v_pk_fma_f32 v[104:105], v[98:99], v[120:121], v[122:123] op_sel:[1,1,0] op_sel_hi:[1,0,1] neg_lo:[1,0,0]
    v_pk_fma_f32 v[106:107], v[100:101], v[120:121], v[124:125] op_sel:[1,1,0] op_sel_hi:[1,0,1] neg_lo:[1,0,0]
    v_pk_fma_f32 v[118:119], v[66:67], v[66:67], v[126:127] op_sel:[1,1,0] op_sel_hi:[1,0,1] neg_lo:[1,0,0]
    v_cvt_pk_bf16_f32 v58, v98, v99
    ds_write_addtid_b32 v58 offset:30960
    v_cvt_pk_bf16_f32 v59, v100, v101
    ds_write_addtid_b32 v59 offset:35088
    v_cvt_pk_bf16_f32 v56, v102, v103
    ds_write_addtid_b32 v56 offset:41280
    v_pk_mul_f32 v[122:123], v[104:105], v[120:121] op_sel:[0,0] op_sel_hi:[0,1]
    v_pk_mul_f32 v[124:125], v[106:107], v[120:121] op_sel:[0,0] op_sel_hi:[0,1]
    v_pk_mul_f32 v[126:127], v[118:119], v[66:67] op_sel:[0,0] op_sel_hi:[0,1]
    v_pk_fma_f32 v[108:109], v[104:105], v[120:121], v[122:123] op_sel:[1,1,0] op_sel_hi:[1,0,1] neg_lo:[1,0,0]
    v_pk_fma_f32 v[110:111], v[106:107], v[120:121], v[124:125] op_sel:[1,1,0] op_sel_hi:[1,0,1] neg_lo:[1,0,0]
    v_pk_fma_f32 v[114:115], v[118:119], v[66:67], v[126:127] op_sel:[1,1,0] op_sel_hi:[1,0,1] neg_lo:[1,0,0]
    v_cvt_pk_bf16_f32 v57, v104, v105
    ds_write_addtid_b32 v57 offset:43344
    v_cvt_pk_bf16_f32 v58, v106, v107
    ds_write_addtid_b32 v58 offset:37152
    v_pk_mul_f32 v[122:123], v[108:109], v[120:121] op_sel:[0,0] op_sel_hi:[0,1]
    v_pk_mul_f32 v[124:125], v[118:119], v[118:119] op_sel:[0,0] op_sel_hi:[0,1]
    v_pk_fma_f32 v[112:113], v[108:109], v[120:121], v[122:123] op_sel:[1,1,0] op_sel_hi:[1,0,1] neg_lo:[1,0,0]
    v_pk_fma_f32 v[116:117], v[118:119], v[118:119], v[124:125] op_sel:[1,1,0] op_sel_hi:[1,0,1] neg_lo:[1,0,0]
    v_cvt_pk_bf16_f32 v59, v108, v109
    ds_write_addtid_b32 v59 offset:45408
    v_cvt_pk_bf16_f32 v56, v110, v111
    ds_write_addtid_b32 v56 offset:39216
    v_cvt_pk_bf16_f32 v57, v112, v113
    ds_write_addtid_b32 v57 offset:47472
    v_xor_b32 v12, 0, v250
    v_mul_u32_u24 v12, 1280, v12
    buffer_load_dwordx4 v[12:15], v12, s[32:35], s59 offen
    s_add_u32 m0, s53, 49536
    v_mov_b32 v55, 0x3f80
    ds_write_addtid_b32 v55 offset:0
    v_pk_mul_f32 v[88:89], v[66:67], v[116:117] op_sel:[0,0] op_sel_hi:[0,1]
    v_pk_mul_f32 v[90:91], v[118:119], v[116:117] op_sel:[0,0] op_sel_hi:[0,1]
    v_pk_mul_f32 v[92:93], v[114:115], v[116:117] op_sel:[0,0] op_sel_hi:[0,1]
    v_pk_mul_f32 v[94:95], v[116:117], v[116:117] op_sel:[0,0] op_sel_hi:[0,1]
    v_pk_fma_f32 v[72:73], v[66:67], v[116:117], v[88:89] op_sel:[1,1,0] op_sel_hi:[1,0,1] neg_lo:[1,0,0]
    v_pk_fma_f32 v[74:75], v[118:119], v[116:117], v[90:91] op_sel:[1,1,0] op_sel_hi:[1,0,1] neg_lo:[1,0,0]
    v_pk_fma_f32 v[76:77], v[114:115], v[116:117], v[92:93] op_sel:[1,1,0] op_sel_hi:[1,0,1] neg_lo:[1,0,0]
    v_pk_fma_f32 v[78:79], v[116:117], v[116:117], v[94:95] op_sel:[1,1,0] op_sel_hi:[1,0,1] neg_lo:[1,0,0]
    v_cvt_pk_bf16_f32 v58, v66, v67
    ds_write_addtid_b32 v58 offset:2064
    v_cvt_pk_bf16_f32 v59, v118, v119
    ds_write_addtid_b32 v59 offset:4128
    v_cvt_pk_bf16_f32 v56, v114, v115
    ds_write_addtid_b32 v56 offset:6192
    v_cvt_pk_bf16_f32 v57, v116, v117
    ds_write_addtid_b32 v57 offset:8256
    v_pk_mul_f32 v[88:89], v[72:73], v[116:117] op_sel:[0,0] op_sel_hi:[0,1]
    v_pk_mul_f32 v[90:91], v[74:75], v[116:117] op_sel:[0,0] op_sel_hi:[0,1]
    v_pk_mul_f32 v[92:93], v[76:77], v[116:117] op_sel:[0,0] op_sel_hi:[0,1]
    v_pk_mul_f32 v[94:95], v[78:79], v[116:117] op_sel:[0,0] op_sel_hi:[0,1]
    v_pk_fma_f32 v[80:81], v[72:73], v[116:117], v[88:89] op_sel:[1,1,0] op_sel_hi:[1,0,1] neg_lo:[1,0,0]
    v_pk_fma_f32 v[82:83], v[74:75], v[116:117], v[90:91] op_sel:[1,1,0] op_sel_hi:[1,0,1] neg_lo:[1,0,0]
    v_pk_fma_f32 v[84:85], v[76:77], v[116:117], v[92:93] op_sel:[1,1,0] op_sel_hi:[1,0,1] neg_lo:[1,0,0]
    v_pk_fma_f32 v[86:87], v[78:79], v[116:117], v[94:95] op_sel:[1,1,0] op_sel_hi:[1,0,1] neg_lo:[1,0,0]
    v_cvt_pk_bf16_f32 v58, v72, v73
    ds_write_addtid_b32 v58 offset:10320
    v_cvt_pk_bf16_f32 v59, v74, v75
    ds_write_addtid_b32 v59 offset:12384
    v_cvt_pk_bf16_f32 v56, v76, v77
    ds_write_addtid_b32 v56 offset:14448
    v_cvt_pk_bf16_f32 v57, v78, v79
    ds_write_addtid_b32 v57 offset:16512
    v_pk_mul_f32 v[88:89], v[80:81], v[116:117] op_sel:[0,0] op_sel_hi:[0,1]
    v_pk_mul_f32 v[90:91], v[82:83], v[116:117] op_sel:[0,0] op_sel_hi:[0,1]
    v_pk_mul_f32 v[92:93], v[84:85], v[116:117] op_sel:[0,0] op_sel_hi:[0,1]
    v_pk_mul_f32 v[94:95], v[86:87], v[116:117] op_sel:[0,0] op_sel_hi:[0,1]
    v_pk_fma_f32 v[72:73], v[80:81], v[116:117], v[88:89] op_sel:[1,1,0] op_sel_hi:[1,0,1] neg_lo:[1,0,0]
    v_pk_fma_f32 v[74:75], v[82:83], v[116:117], v[90:91] op_sel:[1,1,0] op_sel_hi:[1,0,1] neg_lo:[1,0,0]
    v_pk_fma_f32 v[76:77], v[84:85], v[116:117], v[92:93] op_sel:[1,1,0] op_sel_hi:[1,0,1] neg_lo:[1,0,0]
    v_pk_fma_f32 v[78:79], v[86:87], v[116:117], v[94:95] op_sel:[1,1,0] op_sel_hi:[1,0,1] neg_lo:[1,0,0]
    v_cvt_pk_bf16_f32 v58, v80, v81
    ds_write_addtid_b32 v58 offset:18576
    v_cvt_pk_bf16_f32 v59, v82, v83
    ds_write_addtid_b32 v59 offset:20640
    v_cvt_pk_bf16_f32 v56, v84, v85
    ds_write_addtid_b32 v56 offset:22704
    v_cvt_pk_bf16_f32 v57, v86, v87
    ds_write_addtid_b32 v57 offset:24768
    v_pk_mul_f32 v[88:89], v[72:73], v[116:117] op_sel:[0,0] op_sel_hi:[0,1]
    v_pk_mul_f32 v[90:91], v[74:75], v[116:117] op_sel:[0,0] op_sel_hi:[0,1]
    v_pk_mul_f32 v[92:93], v[76:77], v[116:117] op_sel:[0,0] op_sel_hi:[0,1]
    v_pk_mul_f32 v[94:95], v[78:79], v[116:117] op_sel:[0,0] op_sel_hi:[0,1]
    v_pk_fma_f32 v[80:81], v[72:73], v[116:117], v[88:89] op_sel:[1,1,0] op_sel_hi:[1,0,1] neg_lo:[1,0,0]
    v_pk_fma_f32 v[82:83], v[74:75], v[116:117], v[90:91] op_sel:[1,1,0] op_sel_hi:[1,0,1] neg_lo:[1,0,0]
    v_pk_fma_f32 v[84:85], v[76:77], v[116:117], v[92:93] op_sel:[1,1,0] op_sel_hi:[1,0,1] neg_lo:[1,0,0]
    v_pk_fma_f32 v[86:87], v[78:79], v[116:117], v[94:95] op_sel:[1,1,0] op_sel_hi:[1,0,1] neg_lo:[1,0,0]
    v_cvt_pk_bf16_f32 v58, v72, v73
    ds_write_addtid_b32 v58 offset:26832
    v_cvt_pk_bf16_f32 v59, v74, v75
    ds_write_addtid_b32 v59 offset:28896
    v_cvt_pk_bf16_f32 v56, v76, v77
    ds_write_addtid_b32 v56 offset:30960
    v_cvt_pk_bf16_f32 v57, v78, v79
    ds_write_addtid_b32 v57 offset:33024
    v_pk_mul_f32 v[88:89], v[80:81], v[116:117] op_sel:[0,0] op_sel_hi:[0,1]
    v_pk_mul_f32 v[90:91], v[82:83], v[116:117] op_sel:[0,0] op_sel_hi:[0,1]
    v_pk_mul_f32 v[92:93], v[84:85], v[116:117] op_sel:[0,0] op_sel_hi:[0,1]
    v_pk_mul_f32 v[94:95], v[86:87], v[116:117] op_sel:[0,0] op_sel_hi:[0,1]
    v_pk_fma_f32 v[72:73], v[80:81], v[116:117], v[88:89] op_sel:[1,1,0] op_sel_hi:[1,0,1] neg_lo:[1,0,0]
    v_pk_fma_f32 v[74:75], v[82:83], v[116:117], v[90:91] op_sel:[1,1,0] op_sel_hi:[1,0,1] neg_lo:[1,0,0]
    v_pk_fma_f32 v[76:77], v[84:85], v[116:117], v[92:93] op_sel:[1,1,0] op_sel_hi:[1,0,1] neg_lo:[1,0,0]
    v_pk_fma_f32 v[78:79], v[86:87], v[116:117], v[94:95] op_sel:[1,1,0] op_sel_hi:[1,0,1] neg_lo:[1,0,0]
    v_cvt_pk_bf16_f32 v58, v80, v81
    ds_write_addtid_b32 v58 offset:35088
    v_cvt_pk_bf16_f32 v59, v82, v83
    ds_write_addtid_b32 v59 offset:37152
    v_cvt_pk_bf16_f32 v56, v84, v85
    ds_write_addtid_b32 v56 offset:39216
    v_cvt_pk_bf16_f32 v57, v86, v87
    ds_write_addtid_b32 v57 offset:41280
    v_pk_mul_f32 v[88:89], v[72:73], v[116:117] op_sel:[0,0] op_sel_hi:[0,1]
    v_pk_mul_f32 v[90:91], v[74:75], v[116:117] op_sel:[0,0] op_sel_hi:[0,1]
    v_pk_mul_f32 v[92:93], v[76:77], v[116:117] op_sel:[0,0] op_sel_hi:[0,1]
    v_pk_mul_f32 v[94:95], v[78:79], v[116:117] op_sel:[0,0] op_sel_hi:[0,1]
    v_pk_fma_f32 v[80:81], v[72:73], v[116:117], v[88:89] op_sel:[1,1,0] op_sel_hi:[1,0,1] neg_lo:[1,0,0]
    v_pk_fma_f32 v[82:83], v[74:75], v[116:117], v[90:91] op_sel:[1,1,0] op_sel_hi:[1,0,1] neg_lo:[1,0,0]
    v_pk_fma_f32 v[84:85], v[76:77], v[116:117], v[92:93] op_sel:[1,1,0] op_sel_hi:[1,0,1] neg_lo:[1,0,0]
    v_pk_fma_f32 v[86:87], v[78:79], v[116:117], v[94:95] op_sel:[1,1,0] op_sel_hi:[1,0,1] neg_lo:[1,0,0]
    v_cvt_pk_bf16_f32 v58, v72, v73
    ds_write_addtid_b32 v58 offset:43344
    v_cvt_pk_bf16_f32 v59, v74, v75
    ds_write_addtid_b32 v59 offset:45408
    v_cvt_pk_bf16_f32 v56, v76, v77
    ds_write_addtid_b32 v56 offset:47472
    v_cvt_pk_bf16_f32 v57, v78, v79
    ds_write_addtid_b32 v57 offset:49536
    v_pk_mul_f32 v[88:89], v[80:81], v[116:117] op_sel:[0,0] op_sel_hi:[0,1]
    v_pk_mul_f32 v[90:91], v[82:83], v[116:117] op_sel:[0,0] op_sel_hi:[0,1]
    v_pk_mul_f32 v[92:93], v[84:85], v[116:117] op_sel:[0,0] op_sel_hi:[0,1]
    v_pk_fma_f32 v[72:73], v[80:81], v[116:117], v[88:89] op_sel:[1,1,0] op_sel_hi:[1,0,1] neg_lo:[1,0,0]
    v_pk_fma_f32 v[74:75], v[82:83], v[116:117], v[90:91] op_sel:[1,1,0] op_sel_hi:[1,0,1] neg_lo:[1,0,0]
    v_pk_fma_f32 v[76:77], v[84:85], v[116:117], v[92:93] op_sel:[1,1,0] op_sel_hi:[1,0,1] neg_lo:[1,0,0]
    v_cvt_pk_bf16_f32 v58, v80, v81
    ds_write_addtid_b32 v58 offset:51600
    v_cvt_pk_bf16_f32 v59, v82, v83
    ds_write_addtid_b32 v59 offset:53664
    v_cvt_pk_bf16_f32 v56, v84, v85
    ds_write_addtid_b32 v56 offset:55728
    v_cvt_pk_bf16_f32 v57, v86, v87
    ds_write_addtid_b32 v57 offset:57792
    v_cvt_pk_bf16_f32 v58, v72, v73
    ds_write_addtid_b32 v58 offset:59856
    v_cvt_pk_bf16_f32 v59, v74, v75
    ds_write_addtid_b32 v59 offset:61920
    v_cvt_pk_bf16_f32 v56, v76, v77
    ds_write_addtid_b32 v56 offset:63984
    v_xor_b32 v16, 1, v250
    v_mul_u32_u24 v16, 1280, v16
    buffer_load_dwordx4 v[16:19], v16, s[32:35], s59 offen
    ds_read_b128 v[128:131], v4 offset:0
    ds_read_b128 v[132:135], v4 offset:49536
    ds_read_b128 v[136:139], v4 offset:32
    ds_read_b128 v[140:143], v4 offset:49568
    ds_read_b128 v[144:147], v4 offset:64
    ds_read_b128 v[148:151], v4 offset:49600
    ds_read_b128 v[152:155], v4 offset:96
    ds_read_b128 v[156:159], v4 offset:49632
    ds_read_b128 v[160:163], v4 offset:128
    ds_read_b128 v[164:167], v4 offset:49664
    ds_read_b128 v[168:171], v4 offset:160
    ds_read_b128 v[172:175], v4 offset:49696
    ds_read_b128 v[176:179], v4 offset:192
    ds_read_b128 v[180:183], v4 offset:49728
    ds_read_b128 v[184:187], v4 offset:224
    ds_read_b128 v[188:191], v4 offset:49760
    s_waitcnt lgkmcnt(14)
    v_mfma_f32_32x32x16_bf16 v[192:207], v[128:131], v[132:135], 0
    s_waitcnt lgkmcnt(12)
    v_mfma_f32_32x32x16_bf16 v[192:207], v[136:139], v[140:143], v[192:207]
    s_waitcnt lgkmcnt(10)
    v_mfma_f32_32x32x16_bf16 v[192:207], v[144:147], v[148:151], v[192:207]
    s_waitcnt lgkmcnt(8)
    v_mfma_f32_32x32x16_bf16 v[192:207], v[152:155], v[156:159], v[192:207]
    s_waitcnt lgkmcnt(6)
    v_mfma_f32_32x32x16_bf16 v[192:207], v[160:163], v[164:167], v[192:207]
    s_waitcnt lgkmcnt(4)
    v_mfma_f32_32x32x16_bf16 v[192:207], v[168:171], v[172:175], v[192:207]
    s_waitcnt lgkmcnt(2)
    v_mfma_f32_32x32x16_bf16 v[192:207], v[176:179], v[180:183], v[192:207]
    s_waitcnt lgkmcnt(0)
    v_mfma_f32_32x32x16_bf16 v[192:207], v[184:187], v[188:191], v[192:207]
    s_setprio 1
    v_and_b32 v48, 0xffff0000, v28
    v_and_b32 v49, 0xffff0000, v29
    v_and_b32 v50, 0xffff0000, v30
    v_and_b32 v51, 0xffff0000, v31
    v_mul_f32 v48, v48, v60
    v_exp_f32 v48, v48
    v_mul_f32 v49, v49, v63
    v_mul_f32 v70, v50, v61
    v_mul_f32 v71, v51, -v61
    v_cvt_pk_bf16_f32 v48, v48, v48
    v_and_b32 v48, 0xffff0000, v48
    v_mul_f32 v48, v48, -v62
    v_mul_f32 v50, 0x41000000, v49
    v_mul_f32 v51, 0x43800000, v49
    v_mul_f32 v52, 0x41000000, v48
    v_mul_f32 v53, 0x43800000, v48
    v_fract_f32 v49, v49
    v_fract_f32 v50, v50
    v_fract_f32 v51, v51
    v_exp_f32 v48, v48
    v_exp_f32 v52, v52
    v_exp_f32 v53, v53
    v_cos_f32 v64, v49
    v_sin_f32 v65, v49
    v_cos_f32 v66, v50
    v_sin_f32 v67, v50
    v_cos_f32 v68, v51
    v_sin_f32 v69, v51
    s_mov_b32 m0, s53
    v_mul_f32 v64, v64, v48
    v_mul_f32 v65, v65, -v48
    v_mul_f32 v66, v66, v52
    v_mul_f32 v67, v67, v52
    v_mul_f32 v68, v68, v53
    v_mul_f32 v69, v69, -v53

    v_pk_mul_f32 v[122:123], v[70:71], v[64:65] op_sel:[0,0] op_sel_hi:[0,1]
    v_pk_mul_f32 v[124:125], v[64:65], v[64:65] op_sel:[0,0] op_sel_hi:[0,1]
    v_pk_mul_f32 v[126:127], v[68:69], v[68:69] op_sel:[0,0] op_sel_hi:[0,1]
    v_pk_fma_f32 v[72:73], v[70:71], v[64:65], v[122:123] op_sel:[1,1,0] op_sel_hi:[1,0,1] neg_lo:[1,0,0]
    v_pk_fma_f32 v[118:119], v[64:65], v[64:65], v[124:125] op_sel:[1,1,0] op_sel_hi:[1,0,1] neg_lo:[1,0,0]
    v_pk_fma_f32 v[120:121], v[68:69], v[68:69], v[126:127] op_sel:[1,1,0] op_sel_hi:[1,0,1] neg_lo:[1,0,0]
    v_cvt_pk_bf16_f32 v57, v70, v71
    ds_write_addtid_b32 v57 offset:0
    v_pk_mul_f32 v[122:123], v[70:71], v[118:119] op_sel:[0,0] op_sel_hi:[0,1]
    v_pk_mul_f32 v[124:125], v[72:73], v[118:119] op_sel:[0,0] op_sel_hi:[0,1]
    v_pk_mul_f32 v[126:127], v[70:71], v[68:69] op_sel:[0,0] op_sel_hi:[0,1]
    v_pk_fma_f32 v[74:75], v[70:71], v[118:119], v[122:123] op_sel:[1,1,0] op_sel_hi:[1,0,1] neg_lo:[1,0,0]
    v_pk_fma_f32 v[76:77], v[72:73], v[118:119], v[124:125] op_sel:[1,1,0] op_sel_hi:[1,0,1] neg_lo:[1,0,0]
    v_pk_fma_f32 v[78:79], v[70:71], v[68:69], v[126:127] op_sel:[1,1,0] op_sel_hi:[1,0,1] neg_lo:[1,0,0]
    v_cvt_pk_bf16_f32 v58, v72, v73
    ds_write_addtid_b32 v58 offset:2064
    v_cvt_pk_bf16_f32 v59, v74, v75
    ds_write_addtid_b32 v59 offset:4128
    v_cvt_pk_bf16_f32 v56, v78, v79
    ds_write_addtid_b32 v56 offset:18576
    v_pk_mul_f32 v[122:123], v[74:75], v[118:119] op_sel:[0,0] op_sel_hi:[0,1]
    v_pk_mul_f32 v[124:125], v[76:77], v[118:119] op_sel:[0,0] op_sel_hi:[0,1]
    v_pk_mul_f32 v[126:127], v[74:75], v[68:69] op_sel:[0,0] op_sel_hi:[0,1]
    v_pk_fma_f32 v[80:81], v[74:75], v[118:119], v[122:123] op_sel:[1,1,0] op_sel_hi:[1,0,1] neg_lo:[1,0,0]
    v_pk_fma_f32 v[82:83], v[76:77], v[118:119], v[124:125] op_sel:[1,1,0] op_sel_hi:[1,0,1] neg_lo:[1,0,0]
    v_pk_fma_f32 v[84:85], v[74:75], v[68:69], v[126:127] op_sel:[1,1,0] op_sel_hi:[1,0,1] neg_lo:[1,0,0]
    v_cvt_pk_bf16_f32 v57, v76, v77
    ds_write_addtid_b32 v57 offset:6192
    v_cvt_pk_bf16_f32 v58, v80, v81
    ds_write_addtid_b32 v58 offset:8256
    ds_write_addtid_b32 v58 offset:16512
    v_cvt_pk_bf16_f32 v59, v84, v85
    ds_write_addtid_b32 v59 offset:20640
    v_pk_mul_f32 v[122:123], v[80:81], v[118:119] op_sel:[0,0] op_sel_hi:[0,1]
    v_pk_mul_f32 v[124:125], v[82:83], v[118:119] op_sel:[0,0] op_sel_hi:[0,1]
    v_pk_mul_f32 v[126:127], v[80:81], v[68:69] op_sel:[0,0] op_sel_hi:[0,1]
    v_pk_fma_f32 v[86:87], v[80:81], v[118:119], v[122:123] op_sel:[1,1,0] op_sel_hi:[1,0,1] neg_lo:[1,0,0]
    v_pk_fma_f32 v[88:89], v[82:83], v[118:119], v[124:125] op_sel:[1,1,0] op_sel_hi:[1,0,1] neg_lo:[1,0,0]
    v_pk_fma_f32 v[90:91], v[80:81], v[68:69], v[126:127] op_sel:[1,1,0] op_sel_hi:[1,0,1] neg_lo:[1,0,0]
    v_cvt_pk_bf16_f32 v56, v82, v83
    ds_write_addtid_b32 v56 offset:10320
    v_cvt_pk_bf16_f32 v57, v86, v87
    ds_write_addtid_b32 v57 offset:12384
    v_cvt_pk_bf16_f32 v58, v90, v91
    ds_write_addtid_b32 v58 offset:22704
    ds_write_addtid_b32 v58 offset:26832
    v_pk_mul_f32 v[122:123], v[86:87], v[118:119] op_sel:[0,0] op_sel_hi:[0,1]
    v_pk_mul_f32 v[124:125], v[86:87], v[68:69] op_sel:[0,0] op_sel_hi:[0,1]
    v_pk_mul_f32 v[126:127], v[80:81], v[120:121] op_sel:[0,0] op_sel_hi:[0,1]
    v_pk_fma_f32 v[92:93], v[86:87], v[118:119], v[122:123] op_sel:[1,1,0] op_sel_hi:[1,0,1] neg_lo:[1,0,0]
    v_pk_fma_f32 v[94:95], v[86:87], v[68:69], v[124:125] op_sel:[1,1,0] op_sel_hi:[1,0,1] neg_lo:[1,0,0]
    v_pk_fma_f32 v[96:97], v[80:81], v[120:121], v[126:127] op_sel:[1,1,0] op_sel_hi:[1,0,1] neg_lo:[1,0,0]
    v_cvt_pk_bf16_f32 v59, v88, v89
    ds_write_addtid_b32 v59 offset:14448
    v_pk_mul_f32 v[122:123], v[92:93], v[68:69] op_sel:[0,0] op_sel_hi:[0,1]
    v_pk_mul_f32 v[124:125], v[92:93], v[120:121] op_sel:[0,0] op_sel_hi:[0,1]
    v_pk_mul_f32 v[126:127], v[90:91], v[120:121] op_sel:[0,0] op_sel_hi:[0,1]
    v_pk_fma_f32 v[98:99], v[92:93], v[68:69], v[122:123] op_sel:[1,1,0] op_sel_hi:[1,0,1] neg_lo:[1,0,0]
    v_pk_fma_f32 v[100:101], v[92:93], v[120:121], v[124:125] op_sel:[1,1,0] op_sel_hi:[1,0,1] neg_lo:[1,0,0]
    v_pk_fma_f32 v[102:103], v[90:91], v[120:121], v[126:127] op_sel:[1,1,0] op_sel_hi:[1,0,1] neg_lo:[1,0,0]
    v_cvt_pk_bf16_f32 v56, v92, v93
    ds_write_addtid_b32 v56 offset:24768
    v_cvt_pk_bf16_f32 v57, v94, v95
    ds_write_addtid_b32 v57 offset:28896
    v_cvt_pk_bf16_f32 v58, v96, v97
    ds_write_addtid_b32 v58 offset:33024
    v_pk_mul_f32 v[122:123], v[98:99], v[120:121] op_sel:[0,0] op_sel_hi:[0,1]
    v_pk_mul_f32 v[124:125], v[100:101], v[120:121] op_sel:[0,0] op_sel_hi:[0,1]
    v_pk_mul_f32 v[126:127], v[66:67], v[66:67] op_sel:[0,0] op_sel_hi:[0,1]
    v_pk_fma_f32 v[104:105], v[98:99], v[120:121], v[122:123] op_sel:[1,1,0] op_sel_hi:[1,0,1] neg_lo:[1,0,0]
    v_pk_fma_f32 v[106:107], v[100:101], v[120:121], v[124:125] op_sel:[1,1,0] op_sel_hi:[1,0,1] neg_lo:[1,0,0]
    v_pk_fma_f32 v[118:119], v[66:67], v[66:67], v[126:127] op_sel:[1,1,0] op_sel_hi:[1,0,1] neg_lo:[1,0,0]
    v_cvt_pk_bf16_f32 v59, v98, v99
    ds_write_addtid_b32 v59 offset:30960
    v_cvt_pk_bf16_f32 v56, v100, v101
    ds_write_addtid_b32 v56 offset:35088
    v_cvt_pk_bf16_f32 v57, v102, v103
    ds_write_addtid_b32 v57 offset:41280
    v_pk_mul_f32 v[122:123], v[104:105], v[120:121] op_sel:[0,0] op_sel_hi:[0,1]
    v_pk_mul_f32 v[124:125], v[106:107], v[120:121] op_sel:[0,0] op_sel_hi:[0,1]
    v_pk_mul_f32 v[126:127], v[118:119], v[66:67] op_sel:[0,0] op_sel_hi:[0,1]
    v_pk_fma_f32 v[108:109], v[104:105], v[120:121], v[122:123] op_sel:[1,1,0] op_sel_hi:[1,0,1] neg_lo:[1,0,0]
    v_pk_fma_f32 v[110:111], v[106:107], v[120:121], v[124:125] op_sel:[1,1,0] op_sel_hi:[1,0,1] neg_lo:[1,0,0]
    v_pk_fma_f32 v[114:115], v[118:119], v[66:67], v[126:127] op_sel:[1,1,0] op_sel_hi:[1,0,1] neg_lo:[1,0,0]
    v_cvt_pk_bf16_f32 v58, v104, v105
    ds_write_addtid_b32 v58 offset:43344
    v_cvt_pk_bf16_f32 v59, v106, v107
    ds_write_addtid_b32 v59 offset:37152
    v_pk_mul_f32 v[122:123], v[108:109], v[120:121] op_sel:[0,0] op_sel_hi:[0,1]
    v_pk_mul_f32 v[124:125], v[118:119], v[118:119] op_sel:[0,0] op_sel_hi:[0,1]
    v_pk_fma_f32 v[112:113], v[108:109], v[120:121], v[122:123] op_sel:[1,1,0] op_sel_hi:[1,0,1] neg_lo:[1,0,0]
    v_pk_fma_f32 v[116:117], v[118:119], v[118:119], v[124:125] op_sel:[1,1,0] op_sel_hi:[1,0,1] neg_lo:[1,0,0]
    v_cvt_pk_bf16_f32 v56, v108, v109
    ds_write_addtid_b32 v56 offset:45408
    v_cvt_pk_bf16_f32 v57, v110, v111
    ds_write_addtid_b32 v57 offset:39216
    v_cvt_pk_bf16_f32 v58, v112, v113
    ds_write_addtid_b32 v58 offset:47472
    v_xor_b32 v20, 2, v250
    v_mul_u32_u24 v20, 1280, v20
    buffer_load_dwordx4 v[20:23], v20, s[32:35], s59 offen
    s_add_u32 m0, s53, 49536
    v_mov_b32 v55, 0x3f80
    v_pk_mul_f32 v[88:89], v[66:67], v[116:117] op_sel:[0,0] op_sel_hi:[0,1]
    v_pk_mul_f32 v[90:91], v[118:119], v[116:117] op_sel:[0,0] op_sel_hi:[0,1]
    v_pk_mul_f32 v[92:93], v[114:115], v[116:117] op_sel:[0,0] op_sel_hi:[0,1]
    v_pk_mul_f32 v[94:95], v[116:117], v[116:117] op_sel:[0,0] op_sel_hi:[0,1]
    v_pk_fma_f32 v[72:73], v[66:67], v[116:117], v[88:89] op_sel:[1,1,0] op_sel_hi:[1,0,1] neg_lo:[1,0,0]
    v_pk_fma_f32 v[74:75], v[118:119], v[116:117], v[90:91] op_sel:[1,1,0] op_sel_hi:[1,0,1] neg_lo:[1,0,0]
    v_pk_fma_f32 v[76:77], v[114:115], v[116:117], v[92:93] op_sel:[1,1,0] op_sel_hi:[1,0,1] neg_lo:[1,0,0]
    v_pk_fma_f32 v[78:79], v[116:117], v[116:117], v[94:95] op_sel:[1,1,0] op_sel_hi:[1,0,1] neg_lo:[1,0,0]
    v_cvt_pk_bf16_f32 v59, v66, v67
    ds_write_addtid_b32 v59 offset:2064
    v_cvt_pk_bf16_f32 v56, v118, v119
    ds_write_addtid_b32 v56 offset:4128
    v_cvt_pk_bf16_f32 v57, v114, v115
    ds_write_addtid_b32 v57 offset:6192
    v_cvt_pk_bf16_f32 v58, v116, v117
    ds_write_addtid_b32 v58 offset:8256
    v_pk_mul_f32 v[88:89], v[72:73], v[116:117] op_sel:[0,0] op_sel_hi:[0,1]
    v_pk_mul_f32 v[90:91], v[74:75], v[116:117] op_sel:[0,0] op_sel_hi:[0,1]
    v_pk_mul_f32 v[92:93], v[76:77], v[116:117] op_sel:[0,0] op_sel_hi:[0,1]
    v_pk_mul_f32 v[94:95], v[78:79], v[116:117] op_sel:[0,0] op_sel_hi:[0,1]
    v_pk_fma_f32 v[80:81], v[72:73], v[116:117], v[88:89] op_sel:[1,1,0] op_sel_hi:[1,0,1] neg_lo:[1,0,0]
    v_pk_fma_f32 v[82:83], v[74:75], v[116:117], v[90:91] op_sel:[1,1,0] op_sel_hi:[1,0,1] neg_lo:[1,0,0]
    v_pk_fma_f32 v[84:85], v[76:77], v[116:117], v[92:93] op_sel:[1,1,0] op_sel_hi:[1,0,1] neg_lo:[1,0,0]
    v_pk_fma_f32 v[86:87], v[78:79], v[116:117], v[94:95] op_sel:[1,1,0] op_sel_hi:[1,0,1] neg_lo:[1,0,0]
    v_cvt_pk_bf16_f32 v59, v72, v73
    ds_write_addtid_b32 v59 offset:10320
    v_cvt_pk_bf16_f32 v56, v74, v75
    ds_write_addtid_b32 v56 offset:12384
    v_cvt_pk_bf16_f32 v57, v76, v77
    ds_write_addtid_b32 v57 offset:14448
    v_cvt_pk_bf16_f32 v58, v78, v79
    ds_write_addtid_b32 v58 offset:16512
    v_pk_mul_f32 v[88:89], v[80:81], v[116:117] op_sel:[0,0] op_sel_hi:[0,1]
    v_pk_mul_f32 v[90:91], v[82:83], v[116:117] op_sel:[0,0] op_sel_hi:[0,1]
    v_pk_mul_f32 v[92:93], v[84:85], v[116:117] op_sel:[0,0] op_sel_hi:[0,1]
    v_pk_mul_f32 v[94:95], v[86:87], v[116:117] op_sel:[0,0] op_sel_hi:[0,1]
    v_pk_fma_f32 v[72:73], v[80:81], v[116:117], v[88:89] op_sel:[1,1,0] op_sel_hi:[1,0,1] neg_lo:[1,0,0]
    v_pk_fma_f32 v[74:75], v[82:83], v[116:117], v[90:91] op_sel:[1,1,0] op_sel_hi:[1,0,1] neg_lo:[1,0,0]
    v_pk_fma_f32 v[76:77], v[84:85], v[116:117], v[92:93] op_sel:[1,1,0] op_sel_hi:[1,0,1] neg_lo:[1,0,0]
    v_pk_fma_f32 v[78:79], v[86:87], v[116:117], v[94:95] op_sel:[1,1,0] op_sel_hi:[1,0,1] neg_lo:[1,0,0]
    v_cvt_pk_bf16_f32 v59, v80, v81
    ds_write_addtid_b32 v59 offset:18576
    v_cvt_pk_bf16_f32 v56, v82, v83
    ds_write_addtid_b32 v56 offset:20640
    v_cvt_pk_bf16_f32 v57, v84, v85
    ds_write_addtid_b32 v57 offset:22704
    v_cvt_pk_bf16_f32 v58, v86, v87
    ds_write_addtid_b32 v58 offset:24768
    v_pk_mul_f32 v[88:89], v[72:73], v[116:117] op_sel:[0,0] op_sel_hi:[0,1]
    v_pk_mul_f32 v[90:91], v[74:75], v[116:117] op_sel:[0,0] op_sel_hi:[0,1]
    v_pk_mul_f32 v[92:93], v[76:77], v[116:117] op_sel:[0,0] op_sel_hi:[0,1]
    v_pk_mul_f32 v[94:95], v[78:79], v[116:117] op_sel:[0,0] op_sel_hi:[0,1]
    v_pk_fma_f32 v[80:81], v[72:73], v[116:117], v[88:89] op_sel:[1,1,0] op_sel_hi:[1,0,1] neg_lo:[1,0,0]
    v_pk_fma_f32 v[82:83], v[74:75], v[116:117], v[90:91] op_sel:[1,1,0] op_sel_hi:[1,0,1] neg_lo:[1,0,0]
    v_pk_fma_f32 v[84:85], v[76:77], v[116:117], v[92:93] op_sel:[1,1,0] op_sel_hi:[1,0,1] neg_lo:[1,0,0]
    v_pk_fma_f32 v[86:87], v[78:79], v[116:117], v[94:95] op_sel:[1,1,0] op_sel_hi:[1,0,1] neg_lo:[1,0,0]
    v_cvt_pk_bf16_f32 v59, v72, v73
    ds_write_addtid_b32 v59 offset:26832
    v_cvt_pk_bf16_f32 v56, v74, v75
    ds_write_addtid_b32 v56 offset:28896
    v_cvt_pk_bf16_f32 v57, v76, v77
    ds_write_addtid_b32 v57 offset:30960
    v_cvt_pk_bf16_f32 v58, v78, v79
    ds_write_addtid_b32 v58 offset:33024
    v_pk_mul_f32 v[88:89], v[80:81], v[116:117] op_sel:[0,0] op_sel_hi:[0,1]
    v_pk_mul_f32 v[90:91], v[82:83], v[116:117] op_sel:[0,0] op_sel_hi:[0,1]
    v_pk_mul_f32 v[92:93], v[84:85], v[116:117] op_sel:[0,0] op_sel_hi:[0,1]
    v_pk_mul_f32 v[94:95], v[86:87], v[116:117] op_sel:[0,0] op_sel_hi:[0,1]
    v_pk_fma_f32 v[72:73], v[80:81], v[116:117], v[88:89] op_sel:[1,1,0] op_sel_hi:[1,0,1] neg_lo:[1,0,0]
    v_pk_fma_f32 v[74:75], v[82:83], v[116:117], v[90:91] op_sel:[1,1,0] op_sel_hi:[1,0,1] neg_lo:[1,0,0]
    v_pk_fma_f32 v[76:77], v[84:85], v[116:117], v[92:93] op_sel:[1,1,0] op_sel_hi:[1,0,1] neg_lo:[1,0,0]
    v_pk_fma_f32 v[78:79], v[86:87], v[116:117], v[94:95] op_sel:[1,1,0] op_sel_hi:[1,0,1] neg_lo:[1,0,0]
    v_cvt_pk_bf16_f32 v59, v80, v81
    ds_write_addtid_b32 v59 offset:35088
    v_cvt_pk_bf16_f32 v56, v82, v83
    ds_write_addtid_b32 v56 offset:37152
    v_cvt_pk_bf16_f32 v57, v84, v85
    ds_write_addtid_b32 v57 offset:39216
    v_cvt_pk_bf16_f32 v58, v86, v87
    ds_write_addtid_b32 v58 offset:41280
    v_pk_mul_f32 v[88:89], v[72:73], v[116:117] op_sel:[0,0] op_sel_hi:[0,1]
    v_pk_mul_f32 v[90:91], v[74:75], v[116:117] op_sel:[0,0] op_sel_hi:[0,1]
    v_pk_mul_f32 v[92:93], v[76:77], v[116:117] op_sel:[0,0] op_sel_hi:[0,1]
    v_pk_mul_f32 v[94:95], v[78:79], v[116:117] op_sel:[0,0] op_sel_hi:[0,1]
    v_pk_fma_f32 v[80:81], v[72:73], v[116:117], v[88:89] op_sel:[1,1,0] op_sel_hi:[1,0,1] neg_lo:[1,0,0]
    v_pk_fma_f32 v[82:83], v[74:75], v[116:117], v[90:91] op_sel:[1,1,0] op_sel_hi:[1,0,1] neg_lo:[1,0,0]
    v_pk_fma_f32 v[84:85], v[76:77], v[116:117], v[92:93] op_sel:[1,1,0] op_sel_hi:[1,0,1] neg_lo:[1,0,0]
    v_pk_fma_f32 v[86:87], v[78:79], v[116:117], v[94:95] op_sel:[1,1,0] op_sel_hi:[1,0,1] neg_lo:[1,0,0]
    v_cvt_pk_bf16_f32 v59, v72, v73
    ds_write_addtid_b32 v59 offset:43344
    v_cvt_pk_bf16_f32 v56, v74, v75
    ds_write_addtid_b32 v56 offset:45408
    v_cvt_pk_bf16_f32 v57, v76, v77
    ds_write_addtid_b32 v57 offset:47472
    v_cvt_pk_bf16_f32 v58, v78, v79
    ds_write_addtid_b32 v58 offset:49536
    v_pk_mul_f32 v[88:89], v[80:81], v[116:117] op_sel:[0,0] op_sel_hi:[0,1]
    v_pk_mul_f32 v[90:91], v[82:83], v[116:117] op_sel:[0,0] op_sel_hi:[0,1]
    v_pk_mul_f32 v[92:93], v[84:85], v[116:117] op_sel:[0,0] op_sel_hi:[0,1]
    v_pk_fma_f32 v[72:73], v[80:81], v[116:117], v[88:89] op_sel:[1,1,0] op_sel_hi:[1,0,1] neg_lo:[1,0,0]
    v_pk_fma_f32 v[74:75], v[82:83], v[116:117], v[90:91] op_sel:[1,1,0] op_sel_hi:[1,0,1] neg_lo:[1,0,0]
    v_pk_fma_f32 v[76:77], v[84:85], v[116:117], v[92:93] op_sel:[1,1,0] op_sel_hi:[1,0,1] neg_lo:[1,0,0]
    v_cvt_pk_bf16_f32 v59, v80, v81
    ds_write_addtid_b32 v59 offset:51600
    v_cvt_pk_bf16_f32 v56, v82, v83
    ds_write_addtid_b32 v56 offset:53664
    v_cvt_pk_bf16_f32 v57, v84, v85
    ds_write_addtid_b32 v57 offset:55728
    v_cvt_pk_bf16_f32 v58, v86, v87
    ds_write_addtid_b32 v58 offset:57792
    v_cvt_pk_bf16_f32 v59, v72, v73
    ds_write_addtid_b32 v59 offset:59856
    v_cvt_pk_bf16_f32 v56, v74, v75
    ds_write_addtid_b32 v56 offset:61920
    v_cvt_pk_bf16_f32 v57, v76, v77
    ds_write_addtid_b32 v57 offset:63984
    v_xor_b32 v24, 3, v250
    v_mul_u32_u24 v24, 1280, v24
    buffer_load_dwordx4 v[24:27], v24, s[32:35], s59 offen
    ds_read_b128 v[128:131], v4 offset:0
    ds_read_b128 v[132:135], v4 offset:49536
    ds_read_b128 v[136:139], v4 offset:32
    ds_read_b128 v[140:143], v4 offset:49568
    ds_read_b128 v[144:147], v4 offset:64
    ds_read_b128 v[148:151], v4 offset:49600
    ds_read_b128 v[152:155], v4 offset:96
    ds_read_b128 v[156:159], v4 offset:49632
    ds_read_b128 v[160:163], v4 offset:128
    ds_read_b128 v[164:167], v4 offset:49664
    ds_read_b128 v[168:171], v4 offset:160
    ds_read_b128 v[172:175], v4 offset:49696
    ds_read_b128 v[176:179], v4 offset:192
    ds_read_b128 v[180:183], v4 offset:49728
    ds_read_b128 v[184:187], v4 offset:224
    ds_read_b128 v[188:191], v4 offset:49760
    s_waitcnt lgkmcnt(14)
    v_mfma_f32_32x32x16_bf16 v[192:207], v[128:131], v[132:135], v[192:207]
    s_waitcnt lgkmcnt(12)
    v_mfma_f32_32x32x16_bf16 v[192:207], v[136:139], v[140:143], v[192:207]
    s_waitcnt lgkmcnt(10)
    v_mfma_f32_32x32x16_bf16 v[192:207], v[144:147], v[148:151], v[192:207]
    s_waitcnt lgkmcnt(8)
    v_mfma_f32_32x32x16_bf16 v[192:207], v[152:155], v[156:159], v[192:207]
    s_waitcnt lgkmcnt(6)
    v_mfma_f32_32x32x16_bf16 v[192:207], v[160:163], v[164:167], v[192:207]
    s_waitcnt lgkmcnt(4)
    v_mfma_f32_32x32x16_bf16 v[192:207], v[168:171], v[172:175], v[192:207]
    s_waitcnt lgkmcnt(2)
    v_mfma_f32_32x32x16_bf16 v[192:207], v[176:179], v[180:183], v[192:207]
    s_waitcnt lgkmcnt(0)
    v_mfma_f32_32x32x16_bf16 v[192:207], v[184:187], v[188:191], v[192:207]
    s_mov_b32 s46, 0x05040100
    s_mov_b32 s47, 0x07060302
    s_mul_i32 s53, s51, 3072
    s_add_u32 s53, s53, 102400
    v_lshl_add_u32 v48, v1, 4, s53
    v_and_b32 v49, 31, v1
    v_lshrrev_b32 v50, 5, v1
    v_lshlrev_b32 v51, 5, v49
    v_lshl_add_u32 v51, v50, 4, v51
    v_add_u32 v51, s53, v51
    v_and_b32 v52, 1, v1
    v_mul_u32_u24 v52, 192, v52
    v_lshl_add_u32 v52, v50, 6, v52
    v_and_b32 v53, 30, v1
    v_lshl_add_u32 v52, v53, 1, v52
    v_add_u32 v52, s53, v52
    v_lshl_add_u32 v53, v1, 1, s53
    v_mov_b32 v54, s53
    s_add_u32 s54, s53, 4
    v_add_u32 v2, s54, v2
    v_add_u32 v4, 1024, v2
    v_add_u32 v7, 2048, v2
    v_lshlrev_b32 v253, 2, v6
    v_sub_u32 v253, v5, v253
    s_add_u32 s54, s53, 2228
    v_lshl_add_u32 v253, v253, 2, s54

    s_waitcnt vmcnt(4)
    v_lshlrev_b32 v70, 5, v5
    v_and_b32 v254, 1, v6
    v_lshl_add_u32 v254, v254, 9, v70
    v_lshrrev_b32 v71, 1, v6
    v_lshl_add_u32 v254, v71, 4, v254
    v_lshl_add_u32 v70, v6, 4, v70
    v_add_u32 v70, s60, v70
    s_lshl_b32 s53, s52, 12
    s_add_u32 s53, s53, 0

    s_and_b32 s62, s2, 7
    s_lshl_b32 s62, s62, 2
    s_lshr_b32 s63, s2, 6
    s_add_u32 s62, s62, s63
    s_bfe_u32 s63, s2, 0x30003
    s_mov_b32 s36, s8
    s_mov_b32 s37, s9
    s_mov_b32 s38, 819200
    s_mov_b32 s39, 0x20000
    s_mul_i32 s3, s63, 160
    v_add_u32 v72, 0, v1
    v_mul_u32_u24 v73, 6554, v72
    v_lshrrev_b32 v73, 16, v73
    v_mul_u32_u24 v73, 1120, v73
    v_lshl_add_u32 v72, v72, 4, v73
    v_add_u32 v28, s3, v72

    v_add_u32 v72, 64, v1
    v_mul_u32_u24 v73, 6554, v72
    v_lshrrev_b32 v73, 16, v73
    v_mul_u32_u24 v73, 1120, v73
    v_lshl_add_u32 v72, v72, 4, v73
    v_add_u32 v29, s3, v72

    v_add_u32 v72, 128, v1
    v_mul_u32_u24 v73, 6554, v72
    v_lshrrev_b32 v73, 16, v73
    v_mul_u32_u24 v73, 1120, v73
    v_lshl_add_u32 v72, v72, 4, v73
    v_add_u32 v30, s3, v72

    v_add_u32 v72, 192, v1
    v_mul_u32_u24 v73, 6554, v72
    v_lshrrev_b32 v73, 16, v73
    v_mul_u32_u24 v73, 1120, v73
    v_lshl_add_u32 v72, v72, 4, v73
    v_add_u32 v31, s3, v72

    v_add_u32 v72, 256, v1
    v_mul_u32_u24 v73, 6554, v72
    v_lshrrev_b32 v73, 16, v73
    v_mul_u32_u24 v73, 1120, v73
    v_lshl_add_u32 v72, v72, 4, v73
    v_add_u32 v252, s3, v72

    s_mov_b64 exec, 1
    v_add_f32 v192, s57, v192
    s_mov_b64 exec, -1
    v_cvt_pk_bf16_f32 v55, v192, 0

    v_cvt_pk_bf16_f32 v56, v193, v192
    v_cvt_pk_bf16_f32 v57, v194, v193
    v_cvt_pk_bf16_f32 v58, v195, v194
    v_cvt_pk_bf16_f32 v59, v196, v195
    v_cvt_pk_bf16_f32 v60, v197, v197
    v_cvt_pk_bf16_f32 v61, v198, v197
    v_cvt_pk_bf16_f32 v62, v199, v198
    v_cvt_pk_bf16_f32 v63, v199, v199
    v_cvt_pk_bf16_f32 v64, v200, v201
    v_cvt_pk_bf16_f32 v65, v202, v203
    v_and_b32 v66, 0xffff0000, v63
    v_lshrrev_b32 v67, 16, v64
    v_and_b32 v69, 0xffff0000, v64
    v_or_b32 v68, v67, v69

    s_waitcnt vmcnt(0)
    v_and_b32 v251, 1, v250
    v_and_b32 v250, 2, v250
    v_cmp_ne_u32 s[44:45], 0, v250
    v_cmpx_ne_u32 vcc, 0, v251
    v_swap_b32 v12, v16
    v_swap_b32 v20, v24
    v_swap_b32 v13, v17
    v_swap_b32 v21, v25
    v_swap_b32 v14, v18
    v_swap_b32 v22, v26
    v_swap_b32 v15, v19
    v_swap_b32 v23, v27
    s_mov_b64 exec, s[44:45]
    v_swap_b32 v12, v20
    v_swap_b32 v13, v21
    v_swap_b32 v14, v22
    v_swap_b32 v15, v23
    v_swap_b32 v16, v24
    v_swap_b32 v17, v25
    v_swap_b32 v18, v26
    v_swap_b32 v19, v27
    s_mov_b64 exec, -1
    v_perm_b32 v72, v16, v12, s46
    v_perm_b32 v73, v24, v20, s46
    ds_write_b64 v3, v[72:73] offset:0
    v_perm_b32 v74, v16, v12, s47
    v_perm_b32 v75, v24, v20, s47
    ds_write_b64 v3, v[74:75] offset:4608
    v_perm_b32 v76, v17, v13, s46
    v_perm_b32 v77, v25, v21, s46
    ds_write_b64 v3, v[76:77] offset:9216
    v_perm_b32 v78, v17, v13, s47
    v_perm_b32 v79, v25, v21, s47
    ds_write_b64 v3, v[78:79] offset:13824
    v_perm_b32 v80, v18, v14, s46
    v_perm_b32 v81, v26, v22, s46
    ds_write_b64 v3, v[80:81] offset:18432
    v_perm_b32 v82, v18, v14, s47
    v_perm_b32 v83, v26, v22, s47
    ds_write_b64 v3, v[82:83] offset:23040
    v_perm_b32 v84, v19, v15, s46
    v_perm_b32 v85, v27, v23, s46
    ds_write_b64 v3, v[84:85] offset:27648
    v_perm_b32 v86, v19, v15, s47
    v_perm_b32 v87, v27, v23, s47
    ds_write_b64 v3, v[86:87] offset:32256
    v_mov_b32 v3, v70
    s_mul_i32 s44, s64, 5120
    s_mul_i32 s45, s64, 40960
    s_add_u32 s46, s45, 327680
    s_add_u32 s47, s45, 655360
    s_waitcnt lgkmcnt(0)

    s_setprio 1
    s_barrier
    ds_write_b128 v48, v[8:11]
    ds_write_b128 v48, v[8:11] offset:2048
    ds_write_b128 v51, v[56:59] offset:64
    ds_write_b128 v51, v[60:63] offset:1088
    s_mov_b64 exec, 1
    ds_write_b32 v54, v55 offset:60
    s_mov_b64 exec, -1

    ds_read2_b32 v[72:73], v2 offset0:6 offset1:4
    ds_read2_b32 v[74:75], v2 offset0:2 offset1:0
    ds_read2_b32 v[76:77], v4 offset0:6 offset1:4
    ds_read2_b32 v[78:79], v4 offset0:2 offset1:0
    ds_read_b128 v[192:195], v3 offset:480
    ds_read_b128 v[196:199], v3 offset:992
    ds_read_b128 v[200:203], v3 offset:1504
    ds_write_b32 v52, v64 offset:2240
    ds_write_b16 v53, v65 offset:2624
    ds_write_b16_d16_hi v53, v65 offset:2752
    v_add_u32 v54, 2112, v54
    s_mov_b32 exec_lo, 0
    s_mov_b32 exec_hi, 0x80000000
    ds_write2_b32 v54, v63, v63 offset0:0 offset1:1
    ds_write2_b32 v54, v66, v67 offset0:2 offset1:210
    ds_write2_b32 v54, v68, v69 offset0:211 offset1:212
    s_mov_b64 exec, -1

    ds_read_b128 v[204:207], v3 offset:2016
    ds_read_b128 v[208:211], v3 offset:2528
    ds_read_b128 v[212:215], v3 offset:3040
    ds_read_b128 v[216:219], v3 offset:3552
    s_waitcnt lgkmcnt(12)
    v_mfma_f32_16x16x32_bf16 v[160:163], v[72:75], v[192:195], 0
    ds_read2_b32 v[80:81], v2 offset0:38 offset1:36
    v_mfma_f32_16x16x32_bf16 v[164:167], v[76:79], v[192:195], 0
    ds_read_b128 v[220:223], v3 offset:4064
    s_waitcnt lgkmcnt(13)
    v_mfma_f32_16x16x32_bf16 v[164:167], v[72:75], v[196:199], v[164:167]
    ds_read2_b32 v[82:83], v2 offset0:34 offset1:32
    v_mfma_f32_16x16x32_bf16 v[168:171], v[76:79], v[196:199], 0
    ds_read_b128 v[192:195], v3 offset:416
    s_waitcnt lgkmcnt(14)
    v_mfma_f32_16x16x32_bf16 v[168:171], v[72:75], v[200:203], v[168:171]
    ds_read2_b32 v[84:85], v4 offset0:38 offset1:36
    v_mfma_f32_16x16x32_bf16 v[172:175], v[76:79], v[200:203], 0
    ds_read_b128 v[196:199], v3 offset:928
    s_waitcnt lgkmcnt(9)
    v_mfma_f32_16x16x32_bf16 v[172:175], v[72:75], v[204:207], v[172:175]
    ds_read2_b32 v[86:87], v4 offset0:34 offset1:32
    v_mfma_f32_16x16x32_bf16 v[176:179], v[76:79], v[204:207], 0
    ds_read_b128 v[200:203], v3 offset:1440
    s_waitcnt lgkmcnt(10)
    v_mfma_f32_16x16x32_bf16 v[176:179], v[72:75], v[208:211], v[176:179]
    ds_read2_b32 v[96:97], v7 offset0:6 offset1:4
    v_mfma_f32_16x16x32_bf16 v[180:183], v[76:79], v[208:211], 0
    ds_read_b128 v[204:207], v3 offset:1952
    s_waitcnt lgkmcnt(11)
    v_mfma_f32_16x16x32_bf16 v[180:183], v[72:75], v[212:215], v[180:183]
    ds_read2_b32 v[98:99], v7 offset0:2 offset1:0
    v_mfma_f32_16x16x32_bf16 v[184:187], v[76:79], v[212:215], 0
    ds_read_b128 v[208:211], v3 offset:2464
    s_waitcnt lgkmcnt(12)
    v_mfma_f32_16x16x32_bf16 v[184:187], v[72:75], v[216:219], v[184:187]
    ds_read2_b32 v[100:101], v7 offset0:214 offset1:212
    v_mfma_f32_16x16x32_bf16 v[188:191], v[76:79], v[216:219], 0
    ds_read_b128 v[212:215], v3 offset:2976
    s_waitcnt lgkmcnt(12)
    v_mfma_f32_16x16x32_bf16 v[188:191], v[72:75], v[220:223], v[188:191]
    ds_read2_b32 v[102:103], v7 offset0:210 offset1:208
    ds_read_b128 v[216:219], v3 offset:3488
    s_waitcnt lgkmcnt(9)
    v_mfma_f32_16x16x32_bf16 v[160:163], v[80:83], v[192:195], v[160:163]
    ds_read2_b32 v[88:89], v2 offset0:70 offset1:68
    v_mfma_f32_16x16x32_bf16 v[164:167], v[84:87], v[192:195], v[164:167]
    ds_read_b128 v[220:223], v3 offset:4000
    v_mfma_f32_16x16x32_bf16 v[164:167], v[80:83], v[196:199], v[164:167]
    ds_read2_b32 v[90:91], v2 offset0:66 offset1:64
    v_mfma_f32_16x16x32_bf16 v[168:171], v[84:87], v[196:199], v[168:171]
    ds_read_b128 v[192:195], v3 offset:352
    s_add_u32 m0, s44, 0
    s_nop 0
    buffer_load_dwordx4 v28, s[36:39], s45 offen lds
    s_waitcnt lgkmcnt(12)
    v_mfma_f32_16x16x32_bf16 v[168:171], v[80:83], v[200:203], v[168:171]
    ds_read2_b32 v[92:93], v4 offset0:70 offset1:68
    v_mfma_f32_16x16x32_bf16 v[172:175], v[84:87], v[200:203], v[172:175]
    ds_read_b128 v[196:199], v3 offset:864
    s_waitcnt lgkmcnt(12)
    v_mfma_f32_16x16x32_bf16 v[172:175], v[80:83], v[204:207], v[172:175]
    ds_read2_b32 v[94:95], v4 offset0:66 offset1:64
    v_mfma_f32_16x16x32_bf16 v[176:179], v[84:87], v[204:207], v[176:179]
    ds_read_b128 v[200:203], v3 offset:1376
    s_waitcnt lgkmcnt(12)
    v_mfma_f32_16x16x32_bf16 v[176:179], v[80:83], v[208:211], v[176:179]
    ds_read2_b32 v[120:121], v253 offset0:3 offset1:2
    v_mfma_f32_16x16x32_bf16 v[180:183], v[84:87], v[208:211], v[180:183]
    ds_read_b128 v[204:207], v3 offset:1888
    s_waitcnt lgkmcnt(12)
    v_mfma_f32_16x16x32_bf16 v[180:183], v[80:83], v[212:215], v[180:183]
    ds_read2_b32 v[122:123], v253 offset0:1 offset1:0
    v_mfma_f32_16x16x32_bf16 v[184:187], v[84:87], v[212:215], v[184:187]
    ds_read_b128 v[208:211], v3 offset:2400
    s_add_u32 m0, s44, 1024
    s_nop 0
    buffer_load_dwordx4 v29, s[36:39], s45 offen lds
    s_waitcnt lgkmcnt(12)
    v_mfma_f32_16x16x32_bf16 v[184:187], v[80:83], v[216:219], v[184:187]
    ds_read2_b32 v[132:133], v253 offset0:51 offset1:50
    v_mfma_f32_16x16x32_bf16 v[188:191], v[84:87], v[216:219], v[188:191]
    ds_read_b128 v[212:215], v3 offset:2912
    s_waitcnt lgkmcnt(12)
    v_mfma_f32_16x16x32_bf16 v[188:191], v[80:83], v[220:223], v[188:191]
    ds_read2_b32 v[134:135], v253 offset0:49 offset1:48
    ds_read_b128 v[216:219], v3 offset:3424
    s_waitcnt lgkmcnt(9)
    v_mfma_f32_16x16x32_bf16 v[160:163], v[88:91], v[192:195], v[160:163]
    ds_read2_b32 v[72:73], v2 offset0:102 offset1:100
    v_mfma_f32_16x16x32_bf16 v[164:167], v[92:95], v[192:195], v[164:167]
    ds_read_b128 v[220:223], v3 offset:3936
    v_mfma_f32_16x16x32_bf16 v[164:167], v[88:91], v[196:199], v[164:167]
    ds_read2_b32 v[74:75], v2 offset0:98 offset1:96
    v_mfma_f32_16x16x32_bf16 v[168:171], v[92:95], v[196:199], v[168:171]
    ds_read_b128 v[192:195], v3 offset:288
    s_add_u32 m0, s44, 2048
    s_nop 0
    buffer_load_dwordx4 v30, s[36:39], s45 offen lds
    s_waitcnt lgkmcnt(12)
    v_mfma_f32_16x16x32_bf16 v[168:171], v[88:91], v[200:203], v[168:171]
    ds_read2_b32 v[76:77], v4 offset0:102 offset1:100
    v_mfma_f32_16x16x32_bf16 v[172:175], v[92:95], v[200:203], v[172:175]
    ds_read_b128 v[196:199], v3 offset:800
    s_waitcnt lgkmcnt(12)
    v_mfma_f32_16x16x32_bf16 v[172:175], v[88:91], v[204:207], v[172:175]
    ds_read2_b32 v[78:79], v4 offset0:98 offset1:96
    v_mfma_f32_16x16x32_bf16 v[176:179], v[92:95], v[204:207], v[176:179]
    ds_read_b128 v[200:203], v3 offset:1312
    s_waitcnt lgkmcnt(12)
    v_mfma_f32_16x16x32_bf16 v[176:179], v[88:91], v[208:211], v[176:179]
    ds_read2_b32 v[124:125], v253 offset0:19 offset1:18
    v_mfma_f32_16x16x32_bf16 v[180:183], v[92:95], v[208:211], v[180:183]
    ds_read_b128 v[204:207], v3 offset:1824
    s_waitcnt lgkmcnt(12)
    v_mfma_f32_16x16x32_bf16 v[180:183], v[88:91], v[212:215], v[180:183]
    ds_read2_b32 v[126:127], v253 offset0:17 offset1:16
    v_mfma_f32_16x16x32_bf16 v[184:187], v[92:95], v[212:215], v[184:187]
    ds_read_b128 v[208:211], v3 offset:2336
    s_add_u32 m0, s44, 3072
    s_nop 0
    buffer_load_dwordx4 v31, s[36:39], s45 offen lds
    s_waitcnt lgkmcnt(12)
    v_mfma_f32_16x16x32_bf16 v[184:187], v[88:91], v[216:219], v[184:187]
    ds_read2_b32 v[136:137], v253 offset0:67 offset1:66
    v_mfma_f32_16x16x32_bf16 v[188:191], v[92:95], v[216:219], v[188:191]
    ds_read_b128 v[212:215], v3 offset:2848
    s_waitcnt lgkmcnt(12)
    v_mfma_f32_16x16x32_bf16 v[188:191], v[88:91], v[220:223], v[188:191]
    ds_read2_b32 v[138:139], v253 offset0:65 offset1:64
    ds_read_b128 v[216:219], v3 offset:3360
    s_waitcnt lgkmcnt(9)
    v_mfma_f32_16x16x32_bf16 v[160:163], v[72:75], v[192:195], v[160:163]
    ds_read2_b32 v[80:81], v2 offset0:134 offset1:132
    v_mfma_f32_16x16x32_bf16 v[164:167], v[76:79], v[192:195], v[164:167]
    ds_read_b128 v[220:223], v3 offset:3872
    v_mfma_f32_16x16x32_bf16 v[164:167], v[72:75], v[196:199], v[164:167]
    ds_read2_b32 v[82:83], v2 offset0:130 offset1:128
    v_mfma_f32_16x16x32_bf16 v[168:171], v[76:79], v[196:199], v[168:171]
    ds_read_b128 v[192:195], v3 offset:224
    s_add_u32 m0, s44, 4096
    s_nop 0
    buffer_load_dwordx4 v252, s[36:39], s45 offen lds
    s_waitcnt lgkmcnt(12)
    v_mfma_f32_16x16x32_bf16 v[168:171], v[72:75], v[200:203], v[168:171]
    ds_read2_b32 v[84:85], v4 offset0:134 offset1:132
    v_mfma_f32_16x16x32_bf16 v[172:175], v[76:79], v[200:203], v[172:175]
    ds_read_b128 v[196:199], v3 offset:736
    s_waitcnt lgkmcnt(12)
    v_mfma_f32_16x16x32_bf16 v[172:175], v[72:75], v[204:207], v[172:175]
    ds_read2_b32 v[86:87], v4 offset0:130 offset1:128
    v_mfma_f32_16x16x32_bf16 v[176:179], v[76:79], v[204:207], v[176:179]
    ds_read_b128 v[200:203], v3 offset:1248
    s_waitcnt lgkmcnt(12)
    v_mfma_f32_16x16x32_bf16 v[176:179], v[72:75], v[208:211], v[176:179]
    ds_read2_b32 v[128:129], v253 offset0:35 offset1:34
    v_mfma_f32_16x16x32_bf16 v[180:183], v[76:79], v[208:211], v[180:183]
    ds_read_b128 v[204:207], v3 offset:1760
    s_waitcnt lgkmcnt(12)
    v_mfma_f32_16x16x32_bf16 v[180:183], v[72:75], v[212:215], v[180:183]
    ds_read2_b32 v[130:131], v253 offset0:33 offset1:32
    v_mfma_f32_16x16x32_bf16 v[184:187], v[76:79], v[212:215], v[184:187]
    ds_read_b128 v[208:211], v3 offset:2272
    s_add_u32 m0, s44, 40960
    s_nop 0
    buffer_load_dwordx4 v28, s[36:39], s46 offen lds
    s_waitcnt lgkmcnt(12)
    v_mfma_f32_16x16x32_bf16 v[184:187], v[72:75], v[216:219], v[184:187]
    ds_read2_b32 v[140:141], v253 offset0:83 offset1:82
    v_mfma_f32_16x16x32_bf16 v[188:191], v[76:79], v[216:219], v[188:191]
    ds_read_b128 v[212:215], v3 offset:2784
    s_waitcnt lgkmcnt(12)
    v_mfma_f32_16x16x32_bf16 v[188:191], v[72:75], v[220:223], v[188:191]
    ds_read2_b32 v[142:143], v253 offset0:81 offset1:80
    ds_read_b128 v[216:219], v3 offset:3296
    s_waitcnt lgkmcnt(9)
    v_mfma_f32_16x16x32_bf16 v[160:163], v[80:83], v[192:195], v[160:163]
    ds_read2_b32 v[88:89], v2 offset0:166 offset1:164
    v_mfma_f32_16x16x32_bf16 v[164:167], v[84:87], v[192:195], v[164:167]
    ds_read_b128 v[220:223], v3 offset:3808
    v_mfma_f32_16x16x32_bf16 v[164:167], v[80:83], v[196:199], v[164:167]
    ds_read2_b32 v[90:91], v2 offset0:162 offset1:160
    v_mfma_f32_16x16x32_bf16 v[168:171], v[84:87], v[196:199], v[168:171]
    ds_read_b128 v[192:195], v3 offset:160
    s_add_u32 m0, s44, 41984
    s_nop 0
    buffer_load_dwordx4 v29, s[36:39], s46 offen lds
    s_waitcnt lgkmcnt(12)
    v_mfma_f32_16x16x32_bf16 v[168:171], v[80:83], v[200:203], v[168:171]
    ds_read2_b32 v[92:93], v4 offset0:166 offset1:164
    v_mfma_f32_16x16x32_bf16 v[172:175], v[84:87], v[200:203], v[172:175]
    ds_read_b128 v[196:199], v3 offset:672
    s_waitcnt lgkmcnt(12)
    v_mfma_f32_16x16x32_bf16 v[172:175], v[80:83], v[204:207], v[172:175]
    ds_read2_b32 v[94:95], v4 offset0:162 offset1:160
    v_mfma_f32_16x16x32_bf16 v[176:179], v[84:87], v[204:207], v[176:179]
    ds_read_b128 v[200:203], v3 offset:1184
    s_waitcnt lgkmcnt(12)
    v_mfma_f32_16x16x32_bf16 v[176:179], v[80:83], v[208:211], v[176:179]
    ds_read2_b32 v[144:145], v253 offset0:99 offset1:98
    v_mfma_f32_16x16x32_bf16 v[180:183], v[84:87], v[208:211], v[180:183]
    ds_read_b128 v[204:207], v3 offset:1696
    s_waitcnt lgkmcnt(12)
    v_mfma_f32_16x16x32_bf16 v[180:183], v[80:83], v[212:215], v[180:183]
    ds_read2_b32 v[146:147], v253 offset0:97 offset1:96
    v_mfma_f32_16x16x32_bf16 v[184:187], v[84:87], v[212:215], v[184:187]
    ds_read_b128 v[208:211], v3 offset:2208
    s_add_u32 m0, s44, 43008
    s_nop 0
    buffer_load_dwordx4 v30, s[36:39], s46 offen lds
    s_waitcnt lgkmcnt(12)
    v_mfma_f32_16x16x32_bf16 v[184:187], v[80:83], v[216:219], v[184:187]
    ds_read2_b32 v[148:149], v253 offset0:115 offset1:114
    v_mfma_f32_16x16x32_bf16 v[188:191], v[84:87], v[216:219], v[188:191]
    ds_read_b128 v[212:215], v3 offset:2720
    s_waitcnt lgkmcnt(12)
    v_mfma_f32_16x16x32_bf16 v[188:191], v[80:83], v[220:223], v[188:191]
    ds_read2_b32 v[150:151], v253 offset0:113 offset1:112
    ds_read_b128 v[216:219], v3 offset:3232
    s_waitcnt lgkmcnt(9)
    v_mfma_f32_16x16x32_bf16 v[160:163], v[88:91], v[192:195], v[160:163]
    ds_read2_b32 v[72:73], v2 offset0:198 offset1:196
    v_mfma_f32_16x16x32_bf16 v[164:167], v[92:95], v[192:195], v[164:167]
    ds_read_b128 v[220:223], v3 offset:3744
    v_mfma_f32_16x16x32_bf16 v[164:167], v[88:91], v[196:199], v[164:167]
    ds_read2_b32 v[74:75], v2 offset0:194 offset1:192
    v_mfma_f32_16x16x32_bf16 v[168:171], v[92:95], v[196:199], v[168:171]
    ds_read_b128 v[192:195], v3 offset:96
    s_add_u32 m0, s44, 44032
    s_nop 0
    buffer_load_dwordx4 v31, s[36:39], s46 offen lds
    s_waitcnt lgkmcnt(12)
    v_mfma_f32_16x16x32_bf16 v[168:171], v[88:91], v[200:203], v[168:171]
    ds_read2_b32 v[76:77], v4 offset0:198 offset1:196
    v_mfma_f32_16x16x32_bf16 v[172:175], v[92:95], v[200:203], v[172:175]
    ds_read_b128 v[196:199], v3 offset:608
    s_waitcnt lgkmcnt(12)
    v_mfma_f32_16x16x32_bf16 v[172:175], v[88:91], v[204:207], v[172:175]
    ds_read2_b32 v[78:79], v4 offset0:194 offset1:192
    v_mfma_f32_16x16x32_bf16 v[176:179], v[92:95], v[204:207], v[176:179]
    ds_read_b128 v[200:203], v3 offset:1120
    s_waitcnt lgkmcnt(12)
    v_mfma_f32_16x16x32_bf16 v[176:179], v[88:91], v[208:211], v[176:179]
    ds_read2_b32 v[152:153], v253 offset0:131 offset1:130
    v_mfma_f32_16x16x32_bf16 v[180:183], v[92:95], v[208:211], v[180:183]
    ds_read_b128 v[204:207], v3 offset:1632
    s_waitcnt lgkmcnt(12)
    v_mfma_f32_16x16x32_bf16 v[180:183], v[88:91], v[212:215], v[180:183]
    ds_read2_b32 v[154:155], v253 offset0:129 offset1:128
    v_mfma_f32_16x16x32_bf16 v[184:187], v[92:95], v[212:215], v[184:187]
    ds_read_b128 v[208:211], v3 offset:2144
    s_add_u32 m0, s44, 45056
    s_nop 0
    buffer_load_dwordx4 v252, s[36:39], s46 offen lds
    s_waitcnt lgkmcnt(12)
    v_mfma_f32_16x16x32_bf16 v[184:187], v[88:91], v[216:219], v[184:187]
    ds_read2_b32 v[156:157], v253 offset0:147 offset1:146
    v_mfma_f32_16x16x32_bf16 v[188:191], v[92:95], v[216:219], v[188:191]
    ds_read_b128 v[212:215], v3 offset:2656
    s_waitcnt lgkmcnt(12)
    v_mfma_f32_16x16x32_bf16 v[188:191], v[88:91], v[220:223], v[188:191]
    ds_read2_b32 v[158:159], v253 offset0:145 offset1:144
    ds_read_b128 v[216:219], v3 offset:3168
    s_waitcnt lgkmcnt(9)
    v_mfma_f32_16x16x32_bf16 v[160:163], v[72:75], v[192:195], v[160:163]
    ds_read2_b32 v[80:81], v2 offset0:230 offset1:228
    v_mfma_f32_16x16x32_bf16 v[164:167], v[76:79], v[192:195], v[164:167]
    ds_read_b128 v[220:223], v3 offset:3680
    v_mfma_f32_16x16x32_bf16 v[164:167], v[72:75], v[196:199], v[164:167]
    ds_read2_b32 v[82:83], v2 offset0:226 offset1:224
    v_mfma_f32_16x16x32_bf16 v[168:171], v[76:79], v[196:199], v[168:171]
    ds_read_b128 v[192:195], v3 offset:32
    s_waitcnt lgkmcnt(12)
    v_mfma_f32_16x16x32_bf16 v[168:171], v[72:75], v[200:203], v[168:171]
    ds_read2_b32 v[84:85], v4 offset0:230 offset1:228
    v_mfma_f32_16x16x32_bf16 v[172:175], v[76:79], v[200:203], v[172:175]
    ds_read_b128 v[196:199], v3 offset:544
    s_waitcnt lgkmcnt(12)
    v_mfma_f32_16x16x32_bf16 v[172:175], v[72:75], v[204:207], v[172:175]
    ds_read2_b32 v[86:87], v4 offset0:226 offset1:224
    v_mfma_f32_16x16x32_bf16 v[176:179], v[76:79], v[204:207], v[176:179]
    ds_read_b128 v[200:203], v3 offset:1056
    s_waitcnt lgkmcnt(12)
    v_mfma_f32_16x16x32_bf16 v[176:179], v[72:75], v[208:211], v[176:179]
    v_mfma_f32_16x16x32_bf16 v[180:183], v[76:79], v[208:211], v[180:183]
    ds_read_b128 v[204:207], v3 offset:1568
    s_cmp_ge_u32 s64, 4
    s_cbranch_scc1 S_nodma
    s_add_u32 m0, s44, 81920
    s_nop 0
    buffer_load_dwordx4 v28, s[36:39], s47 offen lds
    s_add_u32 m0, s44, 82944
    s_nop 0
    buffer_load_dwordx4 v29, s[36:39], s47 offen lds
    s_add_u32 m0, s44, 83968
    s_nop 0
    buffer_load_dwordx4 v30, s[36:39], s47 offen lds
    s_add_u32 m0, s44, 84992
    s_nop 0
    buffer_load_dwordx4 v31, s[36:39], s47 offen lds
    s_add_u32 m0, s44, 86016
    s_nop 0
    buffer_load_dwordx4 v252, s[36:39], s47 offen lds
S_nodma:
    s_waitcnt lgkmcnt(11)
    v_mfma_f32_16x16x32_bf16 v[180:183], v[72:75], v[212:215], v[180:183]
    v_mfma_f32_16x16x32_bf16 v[184:187], v[76:79], v[212:215], v[184:187]
    ds_read_b128 v[208:211], v3 offset:2080
    s_waitcnt lgkmcnt(10)
    v_mfma_f32_16x16x32_bf16 v[184:187], v[72:75], v[216:219], v[184:187]
    v_mfma_f32_16x16x32_bf16 v[188:191], v[76:79], v[216:219], v[188:191]
    ds_read_b128 v[212:215], v3 offset:2592
    s_waitcnt lgkmcnt(9)
    v_mfma_f32_16x16x32_bf16 v[188:191], v[72:75], v[220:223], v[188:191]
    ds_read_b128 v[216:219], v3 offset:3104
    s_waitcnt lgkmcnt(5)
    v_mfma_f32_16x16x32_bf16 v[160:163], v[80:83], v[192:195], v[160:163]
    v_mfma_f32_16x16x32_bf16 v[164:167], v[84:87], v[192:195], v[164:167]
    ds_read_b128 v[220:223], v3 offset:3616
    v_mfma_f32_16x16x32_bf16 v[164:167], v[80:83], v[196:199], v[164:167]
    v_mfma_f32_16x16x32_bf16 v[168:171], v[84:87], v[196:199], v[168:171]
    ds_read_b128 v[192:195], v3 offset:480
    s_waitcnt lgkmcnt(6)
    v_mfma_f32_16x16x32_bf16 v[168:171], v[80:83], v[200:203], v[168:171]
    v_mfma_f32_16x16x32_bf16 v[172:175], v[84:87], v[200:203], v[172:175]
    ds_read_b128 v[196:199], v3 offset:992
    ds_read_b128 v[224:227], v3 offset:464
    s_waitcnt lgkmcnt(7)
    v_mfma_f32_16x16x32_bf16 v[172:175], v[80:83], v[204:207], v[172:175]
    v_mfma_f32_16x16x32_bf16 v[176:179], v[84:87], v[204:207], v[176:179]
    ds_read_b128 v[200:203], v3 offset:1504
    s_waitcnt lgkmcnt(7)
    v_mfma_f32_16x16x32_bf16 v[176:179], v[80:83], v[208:211], v[176:179]
    v_mfma_f32_16x16x32_bf16 v[180:183], v[84:87], v[208:211], v[180:183]
    ds_read_b128 v[204:207], v3 offset:2016
    ds_read_b128 v[104:107], v3 offset:976
    s_waitcnt lgkmcnt(8)
    v_mfma_f32_16x16x32_bf16 v[180:183], v[80:83], v[212:215], v[180:183]
    v_mfma_f32_16x16x32_bf16 v[184:187], v[84:87], v[212:215], v[184:187]
    ds_read_b128 v[208:211], v3 offset:2528
    s_waitcnt lgkmcnt(8)
    v_mfma_f32_16x16x32_bf16 v[184:187], v[80:83], v[216:219], v[184:187]
    v_mfma_f32_16x16x32_bf16 v[188:191], v[84:87], v[216:219], v[188:191]
    ds_read_b128 v[212:215], v3 offset:3040
    s_waitcnt lgkmcnt(8)
    v_mfma_f32_16x16x32_bf16 v[188:191], v[80:83], v[220:223], v[188:191]
    v_mov_b32 v8, 0
    v_mov_b32 v9, 1
    s_cmp_lg_u32 s64, 0
    s_cbranch_scc1 L_rdi_3
    global_load_dword v9, v8, s[28:29] offset:128 sc1
L_rdi_3:
    s_setprio 0
    s_waitcnt lgkmcnt(5)
    v_mfma_f32_16x16x32_bf16 v[228:231], v[192:195], v[32:35], 0
    v_mfma_f32_16x16x32_bf16 v[232:235], v[192:195], v[36:39], 0
    v_mfma_f32_16x16x32_bf16 v[236:239], v[224:227], v[32:35], 0
    v_mfma_f32_16x16x32_bf16 v[240:243], v[224:227], v[36:39], 0
    v_mfma_f32_16x16x32_bf16 v[244:247], v[192:195], v[40:43], 0
    v_mfma_f32_16x16x32_bf16 v[248:251], v[224:227], v[44:47], 0
    ds_read_b128 v[224:227], v3 offset:1488
    v_mfma_f32_16x16x32_bf16 v[168:171], v[96:99], v[192:195], v[168:171]
    v_mfma_f32_16x16x32_bf16 v[176:179], v[100:103], v[192:195], v[176:179]
    v_cvt_pk_bf16_f32 v24, v160, v161
    v_cvt_pk_bf16_f32 v25, v162, v163
    v_cvt_pk_bf16_f32 v26, v164, v165
    v_cvt_pk_bf16_f32 v27, v166, v167
    s_nop 1
    v_permlane16_swap_b32 v24, v26
    v_permlane16_swap_b32 v25, v27
    buffer_store_dwordx4 v[24:27], v254, s[40:43], s53 offen offset:0 sc1
    v_cvt_pk_bf16_f32 v12, v228, v232
    v_cvt_pk_bf16_f32 v13, v229, v233
    v_cvt_pk_bf16_f32 v14, v230, v234
    v_cvt_pk_bf16_f32 v15, v231, v235
    v_cvt_pk_bf16_f32 v16, v236, v240
    v_cvt_pk_bf16_f32 v17, v237, v241
    v_cvt_pk_bf16_f32 v18, v238, v242
    v_cvt_pk_bf16_f32 v19, v239, v243
    v_cvt_pk_bf16_f32 v20, v244, v248
    v_cvt_pk_bf16_f32 v21, v245, v249
    v_cvt_pk_bf16_f32 v22, v246, v250
    v_cvt_pk_bf16_f32 v23, v247, v251
    s_waitcnt lgkmcnt(3)
    v_mfma_f32_16x16x32_bf16 v[228:231], v[196:199], v[32:35], 0
    v_mfma_f32_16x16x32_bf16 v[232:235], v[196:199], v[36:39], 0
    v_mfma_f32_16x16x32_bf16 v[236:239], v[104:107], v[32:35], 0
    v_mfma_f32_16x16x32_bf16 v[240:243], v[104:107], v[36:39], 0
    v_mfma_f32_16x16x32_bf16 v[244:247], v[196:199], v[40:43], 0
    v_mfma_f32_16x16x32_bf16 v[248:251], v[104:107], v[44:47], 0
    ds_read_b128 v[104:107], v3 offset:2000
    v_mfma_f32_16x16x32_bf16 v[172:175], v[96:99], v[196:199], v[172:175]
    v_mfma_f32_16x16x32_bf16 v[180:183], v[100:103], v[196:199], v[180:183]
    v_mfma_f32_16x16x32_bf16 v[168:171], v[12:15], v[120:123], v[168:171]
    v_mfma_f32_16x16x32_bf16 v[168:171], v[16:19], v[132:135], v[168:171]
    v_cvt_pk_bf16_f32 v108, v228, v232
    v_cvt_pk_bf16_f32 v109, v229, v233
    v_mfma_f32_16x16x32_bf16 v[172:175], v[12:15], v[124:127], v[172:175]
    v_cvt_pk_bf16_f32 v110, v230, v234
    v_cvt_pk_bf16_f32 v111, v231, v235
    v_mfma_f32_16x16x32_bf16 v[176:179], v[12:15], v[128:131], v[176:179]
    v_cvt_pk_bf16_f32 v112, v236, v240
    v_cvt_pk_bf16_f32 v113, v237, v241
    v_mfma_f32_16x16x32_bf16 v[172:175], v[16:19], v[136:139], v[172:175]
    v_cvt_pk_bf16_f32 v114, v238, v242
    v_cvt_pk_bf16_f32 v115, v239, v243
    v_mfma_f32_16x16x32_bf16 v[176:179], v[16:19], v[140:143], v[176:179]
    v_cvt_pk_bf16_f32 v116, v244, v248
    v_cvt_pk_bf16_f32 v117, v245, v249
    v_mfma_f32_16x16x32_bf16 v[176:179], v[20:23], v[144:147], v[176:179]
    v_cvt_pk_bf16_f32 v118, v246, v250
    v_cvt_pk_bf16_f32 v119, v247, v251
    v_mfma_f32_16x16x32_bf16 v[180:183], v[20:23], v[148:151], v[180:183]
    v_mfma_f32_16x16x32_bf16 v[184:187], v[20:23], v[152:155], v[184:187]
    v_mfma_f32_16x16x32_bf16 v[188:191], v[20:23], v[156:159], v[188:191]
    v_cvt_pk_bf16_f32 v24, v168, v169
    v_cvt_pk_bf16_f32 v25, v170, v171
    s_waitcnt lgkmcnt(1)
    v_mfma_f32_16x16x32_bf16 v[228:231], v[200:203], v[32:35], 0
    v_mfma_f32_16x16x32_bf16 v[232:235], v[200:203], v[36:39], 0
    v_mfma_f32_16x16x32_bf16 v[236:239], v[224:227], v[32:35], 0
    v_mfma_f32_16x16x32_bf16 v[240:243], v[224:227], v[36:39], 0
    v_mfma_f32_16x16x32_bf16 v[244:247], v[200:203], v[40:43], 0
    v_mfma_f32_16x16x32_bf16 v[248:251], v[224:227], v[44:47], 0
    ds_read_b128 v[224:227], v3 offset:2512
    v_mfma_f32_16x16x32_bf16 v[176:179], v[96:99], v[200:203], v[176:179]
    v_mfma_f32_16x16x32_bf16 v[184:187], v[100:103], v[200:203], v[184:187]
    v_mfma_f32_16x16x32_bf16 v[172:175], v[108:111], v[120:123], v[172:175]
    v_mfma_f32_16x16x32_bf16 v[172:175], v[112:115], v[132:135], v[172:175]
    v_cvt_pk_bf16_f32 v12, v228, v232
    v_cvt_pk_bf16_f32 v13, v229, v233
    v_mfma_f32_16x16x32_bf16 v[176:179], v[108:111], v[124:127], v[176:179]
    v_cvt_pk_bf16_f32 v14, v230, v234
    v_cvt_pk_bf16_f32 v15, v231, v235
    v_mfma_f32_16x16x32_bf16 v[180:183], v[108:111], v[128:131], v[180:183]
    v_cvt_pk_bf16_f32 v16, v236, v240
    v_cvt_pk_bf16_f32 v17, v237, v241
    v_mfma_f32_16x16x32_bf16 v[176:179], v[112:115], v[136:139], v[176:179]
    v_cvt_pk_bf16_f32 v18, v238, v242
    v_cvt_pk_bf16_f32 v19, v239, v243
    v_mfma_f32_16x16x32_bf16 v[180:183], v[112:115], v[140:143], v[180:183]
    v_cvt_pk_bf16_f32 v20, v244, v248
    v_cvt_pk_bf16_f32 v21, v245, v249
    v_mfma_f32_16x16x32_bf16 v[180:183], v[116:119], v[144:147], v[180:183]
    v_cvt_pk_bf16_f32 v22, v246, v250
    v_cvt_pk_bf16_f32 v23, v247, v251
    v_mfma_f32_16x16x32_bf16 v[184:187], v[116:119], v[148:151], v[184:187]
    v_mfma_f32_16x16x32_bf16 v[188:191], v[116:119], v[152:155], v[188:191]
    s_mov_b32 s44, 0
    s_waitcnt vmcnt(1)
L_rdy_4:
    v_cmp_eq_u32 vcc, 0, v9
    s_cbranch_vccz L_rdy_4x
    s_sleep 4
    global_load_dword v9, v8, s[28:29] offset:128 sc1
    s_add_u32 s44, s44, 1
    s_cmp_lt_u32 s44, 16384
    s_waitcnt vmcnt(0)
    s_cbranch_scc1 L_rdy_4
L_rdy_4x:

    v_cvt_pk_bf16_f32 v26, v172, v173
    v_cvt_pk_bf16_f32 v27, v174, v175
    s_nop 1
    v_permlane16_swap_b32 v24, v26
    v_permlane16_swap_b32 v25, v27
    buffer_store_dwordx4 v[24:27], v254, s[40:43], s53 offen offset:1024 sc1
    s_waitcnt lgkmcnt(1)
    v_mfma_f32_16x16x32_bf16 v[228:231], v[204:207], v[32:35], 0
    v_mfma_f32_16x16x32_bf16 v[232:235], v[204:207], v[36:39], 0
    v_mfma_f32_16x16x32_bf16 v[236:239], v[104:107], v[32:35], 0
    v_mfma_f32_16x16x32_bf16 v[240:243], v[104:107], v[36:39], 0
    v_mfma_f32_16x16x32_bf16 v[244:247], v[204:207], v[40:43], 0
    v_mfma_f32_16x16x32_bf16 v[248:251], v[104:107], v[44:47], 0
    ds_read_b128 v[104:107], v3 offset:3024
    v_mfma_f32_16x16x32_bf16 v[180:183], v[96:99], v[204:207], v[180:183]
    v_mfma_f32_16x16x32_bf16 v[188:191], v[100:103], v[204:207], v[188:191]
    v_mfma_f32_16x16x32_bf16 v[176:179], v[12:15], v[120:123], v[176:179]
    v_mfma_f32_16x16x32_bf16 v[176:179], v[16:19], v[132:135], v[176:179]
    v_cvt_pk_bf16_f32 v108, v228, v232
    v_cvt_pk_bf16_f32 v109, v229, v233
    v_mfma_f32_16x16x32_bf16 v[180:183], v[12:15], v[124:127], v[180:183]
    v_cvt_pk_bf16_f32 v110, v230, v234
    v_cvt_pk_bf16_f32 v111, v231, v235
    v_mfma_f32_16x16x32_bf16 v[184:187], v[12:15], v[128:131], v[184:187]
    v_cvt_pk_bf16_f32 v112, v236, v240
    v_cvt_pk_bf16_f32 v113, v237, v241
    v_mfma_f32_16x16x32_bf16 v[180:183], v[16:19], v[136:139], v[180:183]
    v_cvt_pk_bf16_f32 v114, v238, v242
    v_cvt_pk_bf16_f32 v115, v239, v243
    v_mfma_f32_16x16x32_bf16 v[184:187], v[16:19], v[140:143], v[184:187]
    v_cvt_pk_bf16_f32 v116, v244, v248
    v_cvt_pk_bf16_f32 v117, v245, v249
    v_mfma_f32_16x16x32_bf16 v[184:187], v[20:23], v[144:147], v[184:187]
    v_cvt_pk_bf16_f32 v118, v246, v250
    v_cvt_pk_bf16_f32 v119, v247, v251
    v_mfma_f32_16x16x32_bf16 v[188:191], v[20:23], v[148:151], v[188:191]
    v_cvt_pk_bf16_f32 v24, v176, v177
    v_cvt_pk_bf16_f32 v25, v178, v179
    s_waitcnt lgkmcnt(1)
    v_mfma_f32_16x16x32_bf16 v[228:231], v[208:211], v[32:35], 0
    v_mfma_f32_16x16x32_bf16 v[232:235], v[208:211], v[36:39], 0
    v_mfma_f32_16x16x32_bf16 v[236:239], v[224:227], v[32:35], 0
    v_mfma_f32_16x16x32_bf16 v[240:243], v[224:227], v[36:39], 0
    v_mfma_f32_16x16x32_bf16 v[184:187], v[96:99], v[208:211], v[184:187]
    v_mfma_f32_16x16x32_bf16 v[180:183], v[108:111], v[120:123], v[180:183]
    v_mfma_f32_16x16x32_bf16 v[180:183], v[112:115], v[132:135], v[180:183]
    s_nop 2
    v_cvt_pk_bf16_f32 v12, v228, v232
    s_nop 0
    v_cvt_pk_bf16_f32 v13, v229, v233
    v_mfma_f32_16x16x32_bf16 v[184:187], v[108:111], v[124:127], v[184:187]
    v_cvt_pk_bf16_f32 v14, v230, v234
    v_cvt_pk_bf16_f32 v15, v231, v235
    v_mfma_f32_16x16x32_bf16 v[188:191], v[108:111], v[128:131], v[188:191]
    v_cvt_pk_bf16_f32 v16, v236, v240
    v_cvt_pk_bf16_f32 v17, v237, v241
    v_mfma_f32_16x16x32_bf16 v[184:187], v[112:115], v[136:139], v[184:187]
    v_cvt_pk_bf16_f32 v18, v238, v242
    v_cvt_pk_bf16_f32 v19, v239, v243
    v_mfma_f32_16x16x32_bf16 v[188:191], v[112:115], v[140:143], v[188:191]
    v_mfma_f32_16x16x32_bf16 v[188:191], v[116:119], v[144:147], v[188:191]
    s_cmp_lt_u32 s64, 4
    s_cbranch_scc1 S_wo
    s_waitcnt vmcnt(2)
    s_barrier
S_wo:
    v_cvt_pk_bf16_f32 v26, v180, v181
    v_cvt_pk_bf16_f32 v27, v182, v183
    s_nop 1
    v_permlane16_swap_b32 v24, v26
    v_permlane16_swap_b32 v25, v27
    buffer_store_dwordx4 v[24:27], v254, s[40:43], s53 offen offset:2048 sc1
    s_waitcnt lgkmcnt(0)
    v_mfma_f32_16x16x32_bf16 v[228:231], v[212:215], v[32:35], 0
    v_mfma_f32_16x16x32_bf16 v[232:235], v[212:215], v[36:39], 0
    v_mfma_f32_16x16x32_bf16 v[236:239], v[104:107], v[32:35], 0
    v_mfma_f32_16x16x32_bf16 v[240:243], v[104:107], v[36:39], 0
    v_mfma_f32_16x16x32_bf16 v[188:191], v[96:99], v[212:215], v[188:191]
    v_mfma_f32_16x16x32_bf16 v[184:187], v[12:15], v[120:123], v[184:187]
    v_mfma_f32_16x16x32_bf16 v[184:187], v[16:19], v[132:135], v[184:187]
    s_nop 2
    v_cvt_pk_bf16_f32 v108, v228, v232
    s_nop 0
    v_cvt_pk_bf16_f32 v109, v229, v233
    v_mfma_f32_16x16x32_bf16 v[188:191], v[12:15], v[124:127], v[188:191]
    v_cvt_pk_bf16_f32 v110, v230, v234
    v_cvt_pk_bf16_f32 v111, v231, v235
    v_mfma_f32_16x16x32_bf16 v[188:191], v[16:19], v[136:139], v[188:191]
    v_cvt_pk_bf16_f32 v112, v236, v240
    v_cvt_pk_bf16_f32 v113, v237, v241
    v_cvt_pk_bf16_f32 v114, v238, v242
    v_cvt_pk_bf16_f32 v115, v239, v243
    v_cvt_pk_bf16_f32 v24, v184, v185
    v_cvt_pk_bf16_f32 v25, v186, v187
    s_nop 1
    v_mfma_f32_16x16x32_bf16 v[188:191], v[108:111], v[120:123], v[188:191]
    v_mfma_f32_16x16x32_bf16 v[188:191], v[112:115], v[132:135], v[188:191]
    s_nop 7
    v_cvt_pk_bf16_f32 v26, v188, v189
    v_cvt_pk_bf16_f32 v27, v190, v191
    s_nop 1
    v_permlane16_swap_b32 v24, v26
    v_permlane16_swap_b32 v25, v27
    buffer_store_dwordx4 v[24:27], v254, s[40:43], s53 offen offset:3072 sc1
    s_branch FIN_B
K_help:
    s_and_b32 s62, s2, 7
    s_lshl_b32 s62, s62, 2
    s_lshr_b32 s63, s2, 6
    s_add_u32 s62, s62, s63
    s_bfe_u32 s63, s2, 0x30003
    s_lshr_b32 s47, s2, 3
    s_lshl_b32 s3, s64, 4
    s_add_u32 s47, s47, s3
    s_sub_u32 s47, s47, 16
    s_cmp_ge_u32 s47, 108
    s_cbranch_scc1 L_pf_5q
    s_mul_i32 s44, s47, 3641
    s_lshr_b32 s44, s44, 16
    s_mul_i32 s45, s44, 18
    s_sub_u32 s45, s47, s45
    s_lshl_b32 s44, s44, 2
    s_lshr_b32 s44, 0x948631, s44
    s_and_b32 s44, s44, 15
    s_cmp_ge_u32 s45, 8
    s_cbranch_scc1 L_pf_5w
    s_and_b32 s46, s2, 3
    s_lshl_b32 s46, s46, 3
    s_add_u32 s46, s46, s45
    s_mul_i32 s46, s46, 81920
    s_lshl_b32 s44, s44, 7
    s_add_u32 s46, s46, s44
    v_mul_u32_u24 v254, 1280, v1
    buffer_load_dword v254, v254, s[32:35], s46 offen
    s_branch L_pf_5x
L_pf_5q:
    s_sub_u32 s45, s47, 108
    s_mul_i32 s44, s45, 13108
    s_lshr_b32 s44, s44, 16
    s_mul_i32 s46, s44, 5
    s_sub_u32 s45, s45, s46
    s_branch L_pf_5v
L_pf_5w:
    s_cmp_ge_u32 s45, 13
    s_cselect_b32 s46, 7, 2
    s_add_u32 s45, s45, s46
L_pf_5v:
    s_mul_i32 s44, s44, 245760
    s_lshl_b32 s45, s45, 7
    s_add_u32 s44, s44, s45
    s_bfe_u32 s45, s2, 0x10002
    s_mul_i32 s45, s45, 640
    s_add_u32 s44, s44, s45
    v_mul_u32_u24 v254, 3840, v1
    v_add_u32 v254, s44, v254
    global_load_dword v254, v254, s[6:7]
L_pf_5x:

    s_lshr_b32 s47, s2, 3
    s_mul_i32 s3, s64, 6
    s_add_u32 s47, s47, s3
    s_add_u32 s47, s47, 102
    s_cmp_ge_u32 s47, 158
    s_cbranch_scc1 H_gate
    s_cmp_ge_u32 s47, 108
    s_cbranch_scc1 L_pf_6q
    s_mul_i32 s44, s47, 3641
    s_lshr_b32 s44, s44, 16
    s_mul_i32 s45, s44, 18
    s_sub_u32 s45, s47, s45
    s_lshl_b32 s44, s44, 2
    s_lshr_b32 s44, 0x948631, s44
    s_and_b32 s44, s44, 15
    s_cmp_ge_u32 s45, 8
    s_cbranch_scc1 L_pf_6w
    s_and_b32 s46, s2, 3
    s_lshl_b32 s46, s46, 3
    s_add_u32 s46, s46, s45
    s_mul_i32 s46, s46, 81920
    s_lshl_b32 s44, s44, 7
    s_add_u32 s46, s46, s44
    v_mul_u32_u24 v253, 1280, v1
    buffer_load_dword v253, v253, s[32:35], s46 offen
    s_branch L_pf_6x
L_pf_6q:
    s_sub_u32 s45, s47, 108
    s_mul_i32 s44, s45, 13108
    s_lshr_b32 s44, s44, 16
    s_mul_i32 s46, s44, 5
    s_sub_u32 s45, s45, s46
    s_branch L_pf_6v
L_pf_6w:
    s_cmp_ge_u32 s45, 13
    s_cselect_b32 s46, 7, 2
    s_add_u32 s45, s45, s46
L_pf_6v:
    s_mul_i32 s44, s44, 245760
    s_lshl_b32 s45, s45, 7
    s_add_u32 s44, s44, s45
    s_bfe_u32 s45, s2, 0x10002
    s_mul_i32 s45, s45, 640
    s_add_u32 s44, s44, s45
    v_mul_u32_u24 v253, 3840, v1
    v_add_u32 v253, s44, v253
    global_load_dword v253, v253, s[6:7]
L_pf_6x:

H_gate:
    s_sub_u32 s50, s2, 208
    s_lshl_b32 s52, s50, 3
    s_add_u32 s52, s52, s64
    s_and_b32 s3, s2, 3
    s_lshl_b32 s3, s3, 1
    s_bfe_u32 s44, s2, 0x10002
    s_add_u32 s3, s3, s44
    s_lshl_b32 s3, s3, 2
    s_lshr_b32 s44, s50, 3
    s_add_u32 s3, s3, s44
    s_lshl_b32 s3, s3, 3
    s_add_u32 s3, s3, s64
    s_lshl_b32 s3, s3, 3
    v_lshrrev_b32 v2, 3, v1
    v_add_u32 v2, s3, v2
    v_mul_u32_u24 v3, 1280, v2
    v_and_b32 v4, 7, v1
    v_lshlrev_b32 v5, 4, v4
    v_add_u32 v3, v3, v5
    v_lshlrev_b32 v2, 2, v2

    v_mov_b32 v96, -1
    v_mov_b32 v97, -1
    v_mov_b32 v98, -1
    v_mov_b32 v99, -1
    v_lshlrev_b32 v100, 4, v1
    s_add_u32 s46, s50, 1
    s_and_b32 s46, s46, 7
    s_mul_i32 s46, s46, 5
    s_lshr_b32 s47, s50, 3
    s_add_u32 s46, s46, s47
    s_cmp_ge_u32 s50, 40
    s_cselect_b32 s46, s50, s46
    s_lshl_b32 s46, s46, 3
    s_add_u32 s46, s46, s64
    s_lshl_b32 s46, s46, 13
    s_add_u32 s46, s46, 2621440
    s_add_u32 s47, s46, 4096
    s_cmp_ge_u32 s50, 32
    s_cbranch_scc1 H_flag

    v_cmp_eq_u32 vcc, 0, v4
    s_mov_b32 s3, 6291456
    s_and_saveexec_b64 s[44:45], vcc
    buffer_store_dword v96, v2, s[40:43], s3 offen sc1
    s_mov_b64 exec, -1

    s_branch H_fill
H_flag:
    s_lshl_b32 s3, s52, 7
    s_add_u32 s3, s3, 5734400
    v_lshlrev_b32 v6, 14, v1
    s_mov_b64 exec, 3
    buffer_store_dword v96, v6, s[40:43], s3 offen sc1
    s_mov_b64 exec, -1
H_fill:

    buffer_store_dwordx4 v[96:99], v100, s[40:43], s46 offen offset:0 sc1
    buffer_store_dwordx4 v[96:99], v100, s[40:43], s46 offen offset:1024 sc1
    buffer_store_dwordx4 v[96:99], v100, s[40:43], s46 offen offset:2048 sc1
    buffer_store_dwordx4 v[96:99], v100, s[40:43], s46 offen offset:3072 sc1
    buffer_store_dwordx4 v[96:99], v100, s[40:43], s47 offen offset:0 sc1
    buffer_store_dwordx4 v[96:99], v100, s[40:43], s47 offen offset:1024 sc1
    buffer_store_dwordx4 v[96:99], v100, s[40:43], s47 offen offset:2048 sc1
    buffer_store_dwordx4 v[96:99], v100, s[40:43], s47 offen offset:3072 sc1
    s_mov_b32 s36, s8
    s_mov_b32 s37, s9
    s_mov_b32 s38, 819200
    s_mov_b32 s39, 0x20000
    s_mul_i32 s3, s63, 160
    v_add_u32 v6, 0, v1
    v_mul_u32_u24 v7, 6554, v6
    v_lshrrev_b32 v7, 16, v7
    v_mul_u32_u24 v7, 1120, v7
    v_lshl_add_u32 v6, v6, 4, v7
    v_add_u32 v101, s3, v6

    v_add_u32 v6, 64, v1
    v_mul_u32_u24 v7, 6554, v6
    v_lshrrev_b32 v7, 16, v7
    v_mul_u32_u24 v7, 1120, v7
    v_lshl_add_u32 v6, v6, 4, v7
    v_add_u32 v102, s3, v6

    v_add_u32 v6, 128, v1
    v_mul_u32_u24 v7, 6554, v6
    v_lshrrev_b32 v7, 16, v7
    v_mul_u32_u24 v7, 1120, v7
    v_lshl_add_u32 v6, v6, 4, v7
    v_add_u32 v103, s3, v6

    v_add_u32 v6, 192, v1
    v_mul_u32_u24 v7, 6554, v6
    v_lshrrev_b32 v7, 16, v7
    v_mul_u32_u24 v7, 1120, v7
    v_lshl_add_u32 v6, v6, 4, v7
    v_add_u32 v104, s3, v6

    v_add_u32 v6, 256, v1
    v_mul_u32_u24 v7, 6554, v6
    v_lshrrev_b32 v7, 16, v7
    v_mul_u32_u24 v7, 1120, v7
    v_lshl_add_u32 v6, v6, 4, v7
    v_add_u32 v105, s3, v6

    s_waitcnt vmcnt(0)
    s_barrier
    s_cmp_lg_u32 s64, 0
    s_cbranch_scc1 L_rds_7
    v_mov_b32 v6, 0
    v_mov_b32 v7, 1
    s_mov_b64 exec, 1
    global_atomic_add v7, v6, v7, s[28:29] sc0 sc1
    s_waitcnt vmcnt(0)
    v_cmp_eq_u32 vcc, 47, v7
    s_cbranch_vccz L_rds_7x
    global_store_dword v6, v7, s[28:29] offset:128 sc1
L_rds_7x:
    s_mov_b64 exec, -1
L_rds_7:

    s_cmp_ge_u32 s50, 32
    s_cbranch_scc1 H_nogate
    global_load_dwordx4 v[8:11], v5, s[24:25] offset:0
    buffer_load_dwordx4 v[12:15], v3, s[32:35], 0 offen offset:0
    global_load_dwordx4 v[16:19], v5, s[24:25] offset:128
    buffer_load_dwordx4 v[20:23], v3, s[32:35], 0 offen offset:128
    global_load_dwordx4 v[24:27], v5, s[24:25] offset:256
    buffer_load_dwordx4 v[28:31], v3, s[32:35], 0 offen offset:256
    global_load_dwordx4 v[32:35], v5, s[24:25] offset:384
    buffer_load_dwordx4 v[36:39], v3, s[32:35], 0 offen offset:384
    global_load_dwordx4 v[40:43], v5, s[24:25] offset:512
    buffer_load_dwordx4 v[44:47], v3, s[32:35], 0 offen offset:512
    global_load_dwordx4 v[48:51], v5, s[24:25] offset:640
    buffer_load_dwordx4 v[52:55], v3, s[32:35], 0 offen offset:640
    global_load_dwordx4 v[56:59], v5, s[24:25] offset:768
    buffer_load_dwordx4 v[60:63], v3, s[32:35], 0 offen offset:768
    global_load_dwordx4 v[64:67], v5, s[24:25] offset:896
    buffer_load_dwordx4 v[68:71], v3, s[32:35], 0 offen offset:896
    global_load_dwordx4 v[72:75], v5, s[24:25] offset:1024
    buffer_load_dwordx4 v[76:79], v3, s[32:35], 0 offen offset:1024
    global_load_dwordx4 v[80:83], v5, s[24:25] offset:1152
    buffer_load_dwordx4 v[84:87], v3, s[32:35], 0 offen offset:1152
    v_mov_b32 v6, 0
    v_mov_b32 v7, 0
    s_waitcnt vmcnt(18)
    v_dot2c_f32_bf16 v6, v8, v12
    v_dot2c_f32_bf16 v7, v9, v13
    v_dot2c_f32_bf16 v6, v10, v14
    v_dot2c_f32_bf16 v7, v11, v15
    s_waitcnt vmcnt(16)
    v_dot2c_f32_bf16 v6, v16, v20
    v_dot2c_f32_bf16 v7, v17, v21
    v_dot2c_f32_bf16 v6, v18, v22
    v_dot2c_f32_bf16 v7, v19, v23
    s_waitcnt vmcnt(14)
    v_dot2c_f32_bf16 v6, v24, v28
    v_dot2c_f32_bf16 v7, v25, v29
    v_dot2c_f32_bf16 v6, v26, v30
    v_dot2c_f32_bf16 v7, v27, v31
    s_waitcnt vmcnt(12)
    v_dot2c_f32_bf16 v6, v32, v36
    v_dot2c_f32_bf16 v7, v33, v37
    v_dot2c_f32_bf16 v6, v34, v38
    v_dot2c_f32_bf16 v7, v35, v39
    s_waitcnt vmcnt(10)
    v_dot2c_f32_bf16 v6, v40, v44
    v_dot2c_f32_bf16 v7, v41, v45
    v_dot2c_f32_bf16 v6, v42, v46
    v_dot2c_f32_bf16 v7, v43, v47
    s_waitcnt vmcnt(8)
    v_dot2c_f32_bf16 v6, v48, v52
    v_dot2c_f32_bf16 v7, v49, v53
    v_dot2c_f32_bf16 v6, v50, v54
    v_dot2c_f32_bf16 v7, v51, v55
    s_waitcnt vmcnt(6)
    v_dot2c_f32_bf16 v6, v56, v60
    v_dot2c_f32_bf16 v7, v57, v61
    v_dot2c_f32_bf16 v6, v58, v62
    v_dot2c_f32_bf16 v7, v59, v63
    s_waitcnt vmcnt(4)
    v_dot2c_f32_bf16 v6, v64, v68
    v_dot2c_f32_bf16 v7, v65, v69
    v_dot2c_f32_bf16 v6, v66, v70
    v_dot2c_f32_bf16 v7, v67, v71
    s_waitcnt vmcnt(2)
    v_dot2c_f32_bf16 v6, v72, v76
    v_dot2c_f32_bf16 v7, v73, v77
    v_dot2c_f32_bf16 v6, v74, v78
    v_dot2c_f32_bf16 v7, v75, v79
    s_waitcnt vmcnt(0)
    v_dot2c_f32_bf16 v6, v80, v84
    v_dot2c_f32_bf16 v7, v81, v85
    v_dot2c_f32_bf16 v6, v82, v86
    v_dot2c_f32_bf16 v7, v83, v87
    s_nop 2
    v_add_f32 v6, v6, v7
    s_nop 1
    v_add_f32 v6, v6, v6 quad_perm:[1,0,3,2] row_mask:0xf bank_mask:0xf
    s_nop 1
    v_add_f32 v6, v6, v6 quad_perm:[2,3,0,1] row_mask:0xf bank_mask:0xf
    s_nop 1
    v_add_f32 v6, v6, v6 row_half_mirror row_mask:0xf bank_mask:0xf
    v_mul_f32 v6, 0xbfb8aa3b, v6
    v_exp_f32 v6, v6
    s_nop 0
    v_add_f32 v6, 1.0, v6
    v_rcp_f32 v6, v6
    s_nop 0
    v_and_b32 v6, 0x7fffffff, v6

    v_cmp_eq_u32 vcc, 0, v4
    s_mov_b32 s3, 6291456
    s_and_saveexec_b64 s[44:45], vcc
    buffer_store_dword v6, v2, s[40:43], s3 offen sc1
    s_mov_b64 exec, -1

H_nogate:
    s_mul_i32 s44, s64, 5120
    s_mul_i32 s45, s64, 40960
    s_add_u32 m0, s44, 0
    s_nop 0
    buffer_load_dwordx4 v101, s[36:39], s45 offen lds
    s_add_u32 m0, s44, 1024
    s_nop 0
    buffer_load_dwordx4 v102, s[36:39], s45 offen lds
    s_add_u32 m0, s44, 2048
    s_nop 0
    buffer_load_dwordx4 v103, s[36:39], s45 offen lds
    s_add_u32 m0, s44, 3072
    s_nop 0
    buffer_load_dwordx4 v104, s[36:39], s45 offen lds
    s_add_u32 m0, s44, 4096
    s_nop 0
    buffer_load_dwordx4 v105, s[36:39], s45 offen lds
    s_add_u32 s45, s45, 327680
    s_add_u32 m0, s44, 40960
    s_nop 0
    buffer_load_dwordx4 v101, s[36:39], s45 offen lds
    s_add_u32 m0, s44, 41984
    s_nop 0
    buffer_load_dwordx4 v102, s[36:39], s45 offen lds
    s_add_u32 m0, s44, 43008
    s_nop 0
    buffer_load_dwordx4 v103, s[36:39], s45 offen lds
    s_add_u32 m0, s44, 44032
    s_nop 0
    buffer_load_dwordx4 v104, s[36:39], s45 offen lds
    s_add_u32 m0, s44, 45056
    s_nop 0
    buffer_load_dwordx4 v105, s[36:39], s45 offen lds
    s_add_u32 s45, s45, 327680
    s_cmp_ge_u32 s64, 4
    s_cbranch_scc1 H_wait
    s_add_u32 m0, s44, 81920
    s_nop 0
    buffer_load_dwordx4 v101, s[36:39], s45 offen lds
    s_add_u32 m0, s44, 82944
    s_nop 0
    buffer_load_dwordx4 v102, s[36:39], s45 offen lds
    s_add_u32 m0, s44, 83968
    s_nop 0
    buffer_load_dwordx4 v103, s[36:39], s45 offen lds
    s_add_u32 m0, s44, 84992
    s_nop 0
    buffer_load_dwordx4 v104, s[36:39], s45 offen lds
    s_add_u32 m0, s44, 86016
    s_nop 0
    buffer_load_dwordx4 v105, s[36:39], s45 offen lds
    s_add_u32 s45, s45, 327680
H_wait:
    s_waitcnt vmcnt(0)
    v_mov_b32 v252, 0
    v_mov_b32 v253, 1
    s_cmp_lg_u32 s64, 0
    s_cbranch_scc1 L_rdi_8
    global_load_dword v253, v252, s[28:29] offset:128 sc1
L_rdi_8:
    s_mov_b32 s44, 0
    s_waitcnt vmcnt(0)
L_rdy_9:
    v_cmp_eq_u32 vcc, 0, v253
    s_cbranch_vccz L_rdy_9x
    s_sleep 4
    global_load_dword v253, v252, s[28:29] offset:128 sc1
    s_add_u32 s44, s44, 1
    s_cmp_lt_u32 s44, 16384
    s_waitcnt vmcnt(0)
    s_cbranch_scc1 L_rdy_9
L_rdy_9x:

    s_barrier
FIN_B:
    s_mov_b32 s58, 51200
    s_mov_b32 s59, 102400
FIN:
    s_and_b32 s44, s64, 3
    s_lshr_b32 s45, s64, 2
    s_lshl_b32 s46, s62, 2
    s_add_u32 s46, s46, s44
    s_lshl_b32 s47, s46, 1
    s_add_u32 s47, s47, s45
    s_mul_i32 s47, s47, 10240
    s_add_u32 s47, s47, 2621440
    s_add_u32 s48, s47, 2560
    s_add_u32 s49, s47, 5120
    s_add_u32 s50, s47, 7680
    s_mul_i32 s51, s63, 80
    s_lshl_b32 s52, s51, 12
    s_lshl_b32 s53, s46, 5
    s_add_u32 s52, s52, s53
    s_add_u32 s52, s52, 0
    s_add_u32 s53, s52, 131072
    s_lshl_b32 s54, s46, 6
    s_add_u32 s54, s54, 6291456
    v_lshlrev_b32 v4, 4, v1
    v_lshlrev_b32 v5, 3, v1
    v_lshrrev_b32 v6, 1, v1
    v_lshlrev_b32 v6, 12, v6
    v_and_b32 v7, 1, v1
    v_lshl_add_u32 v6, v7, 4, v6
    v_cmp_gt_u32 vcc, 10, v1
    v_and_b32 v8, 15, v1
    v_lshlrev_b32 v21, 2, v8
    s_mul_i32 s99, s63, 1280
    s_add_u32 s99, s99, 5767168
    v_lshl_add_u32 v7, v1, 7, s99
    s_lshr_b32 s99, s62, 1
    s_lshl_b32 s99, s99, 10
    s_add_u32 s99, s99, 5783552
    v_lshl_add_u32 v20, v8, 7, s99
    v_cndmask_b32 v20, v20, v7, vcc
    s_add_u32 s98, s52, 262144
    v_mov_b32 v7, 0

    s_mul_i32 s55, s45, s58
    v_and_b32 v27, 3, v1
    v_lshrrev_b32 v2, 2, v1
    v_mul_u32_u24 v2, 160, v2
    v_add_u32 v2, s55, v2
    v_bfe_u32 v10, v1, 2, 2
    v_mul_u32_u24 v10, 20, v10
    v_lshrrev_b32 v9, 4, v1
    v_add3_u32 v10, v10, v9, 16
    v_mul_u32_u24 v10, 160, v10
    v_add_u32 v10, s55, v10
    v_lshl_add_u32 v3, v27, 3, v2
    v_lshl_add_u32 v11, v27, 3, v10
    v_lshrrev_b32 v0, 1, v27
    v_lshlrev_b32 v0, 3, v0
    v_lshl_add_u32 v0, v27, 4, v0
    v_add_u32 v2, v2, v0
    v_add_u32 v10, v10, v0
    v_xor_b32 v0, 8, v2
    v_xor_b32 v27, 8, v10

    s_cmp_ge_u32 s2, 208
    s_cbranch_scc1 F_pre
    s_cmp_ge_u32 s2, 128
    s_cbranch_scc1 F_ssm
    s_cmp_eq_u32 s45, 0
    s_cbranch_scc1 F_pre
    s_barrier
    s_branch F_pre
F_lo:

    s_mov_b64 exec, 0xff0000
    buffer_load_dword v25, v20, s[40:43], 0 offen sc1
    s_mov_b64 exec, -1
    s_branch F_pre
F_ssm:
    s_cmp_lg_u32 s45, 0
    s_cbranch_scc1 F_pre
    s_waitcnt vmcnt(4)
    s_barrier
F_pre:

    ds_read_b64_tr_b16 v[88:89], v2 offset:0
    ds_read_b64_tr_b16 v[90:91], v2 offset:3200
    v_mov_b32 v68, 0
    ds_read_b64_tr_b16 v[92:93], v0 offset:0
    ds_read_b64_tr_b16 v[94:95], v0 offset:3200
    v_mov_b32 v69, 0
    ds_read_b64_tr_b16 v[96:97], v2 offset:64
    ds_read_b64_tr_b16 v[98:99], v2 offset:3264
    v_mov_b32 v70, 0
    ds_read_b64_tr_b16 v[100:101], v0 offset:64
    ds_read_b64_tr_b16 v[102:103], v0 offset:3264
    v_mov_b32 v71, 0
    ds_read_b64_tr_b16 v[104:105], v3 offset:128
    ds_read_b64_tr_b16 v[106:107], v3 offset:3328
    v_mov_b32 v72, 0
    ds_read_b64_tr_b16 v[108:109], v2 offset:6400
    ds_read_b64_tr_b16 v[110:111], v2 offset:9600
    v_mov_b32 v73, 0
    ds_read_b64_tr_b16 v[112:113], v0 offset:6400
    ds_read_b64_tr_b16 v[114:115], v0 offset:9600
    v_mov_b32 v74, 0
    ds_read_b64_tr_b16 v[116:117], v2 offset:6464
    ds_read_b64_tr_b16 v[118:119], v2 offset:9664
    v_mov_b32 v75, 0
    ds_read_b64_tr_b16 v[120:121], v0 offset:6464
    ds_read_b64_tr_b16 v[122:123], v0 offset:9664
    v_mov_b32 v76, 0
    ds_read_b64_tr_b16 v[124:125], v3 offset:6528
    ds_read_b64_tr_b16 v[126:127], v3 offset:9728
    v_mov_b32 v77, 0
    ds_read_b64_tr_b16 v[128:129], v2 offset:12800
    ds_read_b64_tr_b16 v[130:131], v2 offset:16000
    v_mov_b32 v78, 0
    ds_read_b64_tr_b16 v[132:133], v0 offset:12800
    ds_read_b64_tr_b16 v[134:135], v0 offset:16000
    v_mov_b32 v79, 0
    ds_read_b64_tr_b16 v[136:137], v2 offset:12864
    ds_read_b64_tr_b16 v[138:139], v2 offset:16064
    v_mov_b32 v80, 0
    ds_read_b64_tr_b16 v[140:141], v0 offset:12864
    ds_read_b64_tr_b16 v[142:143], v0 offset:16064
    v_mov_b32 v81, 0
    ds_read_b64_tr_b16 v[144:145], v3 offset:12928
    ds_read_b64_tr_b16 v[146:147], v3 offset:16128
    v_mov_b32 v82, 0
    ds_read_b64_tr_b16 v[148:149], v2 offset:19200
    ds_read_b64_tr_b16 v[150:151], v2 offset:22400
    v_mov_b32 v83, 0
    ds_read_b64_tr_b16 v[152:153], v0 offset:19200
    ds_read_b64_tr_b16 v[154:155], v0 offset:22400
    v_mov_b32 v84, 0
    ds_read_b64_tr_b16 v[156:157], v2 offset:19264
    ds_read_b64_tr_b16 v[158:159], v2 offset:22464
    v_mov_b32 v85, 0
    ds_read_b64_tr_b16 v[160:161], v0 offset:19264
    ds_read_b64_tr_b16 v[162:163], v0 offset:22464
    v_mov_b32 v86, 0
    ds_read_b64_tr_b16 v[164:165], v3 offset:19328
    ds_read_b64_tr_b16 v[166:167], v3 offset:22528
    v_mov_b32 v87, 0
    ds_read_b64_tr_b16 v[168:169], v10 offset:0
    ds_read_b64_tr_b16 v[170:171], v10 offset:12800
    ds_read_b64_tr_b16 v[172:173], v2 offset:25600
    ds_read_b64_tr_b16 v[174:175], v2 offset:28800
    ds_read_b64_tr_b16 v[176:177], v0 offset:25600
    ds_read_b64_tr_b16 v[178:179], v0 offset:28800
    ds_read_b64_tr_b16 v[180:181], v2 offset:25664
    ds_read_b64_tr_b16 v[182:183], v2 offset:28864
    ds_read_b64_tr_b16 v[184:185], v0 offset:25664
    ds_read_b64_tr_b16 v[186:187], v0 offset:28864
    ds_read_b64_tr_b16 v[188:189], v3 offset:25728
    ds_read_b64_tr_b16 v[190:191], v3 offset:28928
    ds_read_b64_tr_b16 v[192:193], v2 offset:32000
    ds_read_b64_tr_b16 v[194:195], v2 offset:35200
    ds_read_b64_tr_b16 v[196:197], v0 offset:32000
    ds_read_b64_tr_b16 v[198:199], v0 offset:35200
    ds_read_b64_tr_b16 v[200:201], v2 offset:32064
    ds_read_b64_tr_b16 v[202:203], v2 offset:35264
    ds_read_b64_tr_b16 v[204:205], v0 offset:32064
    ds_read_b64_tr_b16 v[206:207], v0 offset:35264
    ds_read_b64_tr_b16 v[208:209], v3 offset:32128
    ds_read_b64_tr_b16 v[210:211], v3 offset:35328
    ds_read_b64_tr_b16 v[212:213], v2 offset:38400
    ds_read_b64_tr_b16 v[214:215], v2 offset:41600
    ds_read_b64_tr_b16 v[216:217], v0 offset:38400
    ds_read_b64_tr_b16 v[218:219], v0 offset:41600
    ds_read_b64_tr_b16 v[220:221], v2 offset:38464
    ds_read_b64_tr_b16 v[222:223], v2 offset:41664
    ds_read_b64_tr_b16 v[224:225], v0 offset:38464
    ds_read_b64_tr_b16 v[226:227], v0 offset:41664
    ds_read_b64_tr_b16 v[228:229], v3 offset:38528
    ds_read_b64_tr_b16 v[230:231], v3 offset:41728
    ds_read_b64_tr_b16 v[232:233], v2 offset:44800
    ds_read_b64_tr_b16 v[234:235], v2 offset:48000
    ds_read_b64_tr_b16 v[236:237], v0 offset:44800
    ds_read_b64_tr_b16 v[238:239], v0 offset:48000
    ds_read_b64_tr_b16 v[240:241], v2 offset:44864
    ds_read_b64_tr_b16 v[242:243], v2 offset:48064
    ds_read_b64_tr_b16 v[244:245], v0 offset:44864
    ds_read_b64_tr_b16 v[246:247], v0 offset:48064
    ds_read_b64_tr_b16 v[248:249], v3 offset:44928
    ds_read_b64_tr_b16 v[250:251], v3 offset:48128
    ds_read_b64_tr_b16 v[252:253], v10 offset:25600
    ds_read_b64_tr_b16 v[254:255], v10 offset:38400
    s_sub_u32 s3, s2, 128
    s_cmp_ge_u32 s3, 80
    s_cbranch_scc1 F_mid
    s_waitcnt vmcnt(0)
    s_barrier
    s_cmp_lg_u32 s64, 4
    s_cbranch_scc1 F_mid
    s_mov_b64 exec, 1
    buffer_store_dword v7, v7, s[40:43], s97 offen sc1
    s_mov_b64 exec, -1
F_mid:
    s_mov_b32 s56, 3
    s_mov_b32 s57, 0
    s_mov_b64 s[60:61], -1
    s_mul_i32 s55, s44, 8192
    s_add_u32 s55, s55, s59
    v_lshrrev_b32 v12, 1, v9
    v_lshlrev_b32 v12, 7, v12
    v_lshl_add_u32 v12, v9, 8, v12
    v_lshl_add_u32 v12, v8, 3, v12
    v_add_u32 v12, s55, v12
    v_xor_b32 v13, 128, v12
    v_add_u32 v14, s55, v5
    v_add_u32 v15, s55, v4
    v_mul_u32_u24 v16, 1280, v8
    v_lshl_add_u32 v17, v9, 3, v16
    v_lshl_add_u32 v16, v9, 4, v16
    s_mul_i32 s46, s46, 20480
    s_lshl_b32 s51, s51, 1
    s_add_u32 s46, s46, s51
    s_waitcnt lgkmcnt(0)

    s_mov_b32 s36, s26
    s_mov_b32 s37, s27
    s_mov_b32 s38, 2621440
    s_mov_b32 s39, 0x20000
    s_mov_b32 s96, 0
    s_cmp_lg_u32 s45, 0
    s_cbranch_scc1 F_go
    s_mov_b32 s99, 0xff0000
    s_cmp_ge_u32 s2, 128
    s_cbranch_scc1 F_id0
    s_waitcnt vmcnt(0)
    s_barrier

F_id0:

F_idle:
    s_or_b32 exec_lo, s99, 0
    s_mov_b32 exec_hi, 0
    buffer_load_dword v25, v20, s[40:43], 0 offen sc1
    s_add_u32 s57, s57, 1
    s_waitcnt vmcnt(0)
F_chk:
    v_cmp_eq_u32 vcc, -1, v25
    s_mov_b64 exec, -1
    s_and_b32 s3, vcc_lo, 0x3ff
    s_or_b32 s3, s3, 1
    s_cbranch_scc1 F_nob
    s_mov_b32 s96, 1

    s_add_u32 m0, s55, 0
    s_nop 0
    buffer_load_dwordx4 v6, s[40:43], s52 offen  lds
    s_add_u32 m0, s55, 1024
    s_nop 0
    buffer_load_dwordx4 v6, s[40:43], s53 offen  lds
    s_add_u32 m0, s55, 2048
    s_mov_b32 exec_hi, 0
    buffer_load_dwordx4 v6, s[40:43], s98 offen  lds
    s_mov_b32 exec_hi, -1
F_nob:
    s_and_b32 s3, vcc_lo, s99
    s_cbranch_scc0 F_seen
    s_cmp_lt_u32 s57, 16384
    s_cbranch_scc1 F_idle
F_seen:
    s_mov_b32 s57, 0

    buffer_load_dwordx2 v[44:45], v5, s[40:43], s47 offen offset:2048 sc1
    buffer_load_dwordx4 v[28:31], v4, s[40:43], s47 offen sc1
    buffer_load_dwordx4 v[32:35], v4, s[40:43], s47 offen offset:1024 sc1
    buffer_load_dwordx2 v[46:47], v5, s[40:43], s48 offen offset:2048 sc1
    buffer_load_dwordx4 v[36:39], v4, s[40:43], s48 offen sc1
    buffer_load_dwordx4 v[40:43], v4, s[40:43], s48 offen offset:1024 sc1
    buffer_load_dwordx2 v[64:65], v5, s[40:43], s49 offen offset:2048 sc1
    buffer_load_dwordx4 v[48:51], v4, s[40:43], s49 offen sc1
    buffer_load_dwordx4 v[52:55], v4, s[40:43], s49 offen offset:1024 sc1
    buffer_load_dwordx2 v[66:67], v5, s[40:43], s50 offen offset:2048 sc1
    buffer_load_dwordx4 v[56:59], v4, s[40:43], s50 offen sc1
    buffer_load_dwordx4 v[60:63], v4, s[40:43], s50 offen offset:1024 sc1
    s_barrier
    s_branch F_in
F_go:
    s_barrier
    buffer_load_dwordx2 v[44:45], v5, s[40:43], s47 offen offset:2048 sc1
    buffer_load_dwordx4 v[28:31], v4, s[40:43], s47 offen sc1
    buffer_load_dwordx4 v[32:35], v4, s[40:43], s47 offen offset:1024 sc1
    buffer_load_dwordx2 v[46:47], v5, s[40:43], s48 offen offset:2048 sc1
    buffer_load_dwordx4 v[36:39], v4, s[40:43], s48 offen sc1
    buffer_load_dwordx4 v[40:43], v4, s[40:43], s48 offen offset:1024 sc1
    buffer_load_dwordx2 v[64:65], v5, s[40:43], s49 offen offset:2048 sc1
    buffer_load_dwordx4 v[48:51], v4, s[40:43], s49 offen sc1
    buffer_load_dwordx4 v[52:55], v4, s[40:43], s49 offen offset:1024 sc1
    buffer_load_dwordx2 v[66:67], v5, s[40:43], s50 offen offset:2048 sc1
    buffer_load_dwordx4 v[56:59], v4, s[40:43], s50 offen sc1
    buffer_load_dwordx4 v[60:63], v4, s[40:43], s50 offen offset:1024 sc1
F_in:
    buffer_load_dword v26, v21, s[40:43], s54 offen sc1
    s_or_b32 s3, s96, s45
    s_cbranch_scc1 F_nrp
    s_mov_b64 exec, 0x3ff
    buffer_load_dword v25, v20, s[40:43], 0 offen sc1
    s_mov_b64 exec, -1
F_nrp:
FL_loop:
    s_bitcmp1_b32 s56, 0
    s_cbranch_scc0 FL_n0
    s_waitcnt vmcnt(7)
    v_max3_u32 v1, v28, v32, v36
    v_max3_u32 v1, v1, v40, v44
    v_max_u32 v1, v1, v46
    v_cmp_eq_u32 vcc, -1, v1
    s_and_b64 vcc, vcc, s[60:61]
    s_cbranch_scc1 FL_n0
    s_bitset0_b32 s56, 0

    v_mfma_f32_16x16x32_bf16 v[68:71], v[88:91], v[28:31], v[68:71]
    v_mfma_f32_16x16x32_bf16 v[72:75], v[92:95], v[28:31], v[72:75]
    v_mfma_f32_16x16x32_bf16 v[76:79], v[96:99], v[28:31], v[76:79]
    ds_read_b64_tr_b16 v[88:89], v27 offset:0
    ds_read_b64_tr_b16 v[90:91], v27 offset:12800
    v_mfma_f32_16x16x32_bf16 v[80:83], v[100:103], v[28:31], v[80:83]
    ds_read_b64_tr_b16 v[92:93], v10 offset:64
    ds_read_b64_tr_b16 v[94:95], v10 offset:12864
    v_mfma_f32_16x16x32_bf16 v[84:87], v[104:107], v[28:31], v[84:87]
    ds_read_b64_tr_b16 v[96:97], v27 offset:64
    ds_read_b64_tr_b16 v[98:99], v27 offset:12864
    v_mfma_f32_16x16x32_bf16 v[68:71], v[108:111], v[32:35], v[68:71]
    ds_read_b64_tr_b16 v[100:101], v11 offset:128
    ds_read_b64_tr_b16 v[102:103], v11 offset:12928
    v_mfma_f32_16x16x32_bf16 v[72:75], v[112:115], v[32:35], v[72:75]
    v_mfma_f32_16x16x32_bf16 v[76:79], v[116:119], v[32:35], v[76:79]
    v_mfma_f32_16x16x32_bf16 v[80:83], v[120:123], v[32:35], v[80:83]
    v_mfma_f32_16x16x32_bf16 v[84:87], v[124:127], v[32:35], v[84:87]
    v_mfma_f32_16x16x32_bf16 v[68:71], v[128:131], v[36:39], v[68:71]
    v_mfma_f32_16x16x32_bf16 v[72:75], v[132:135], v[36:39], v[72:75]
    v_mfma_f32_16x16x32_bf16 v[76:79], v[136:139], v[36:39], v[76:79]
    v_mfma_f32_16x16x32_bf16 v[80:83], v[140:143], v[36:39], v[80:83]
    v_mfma_f32_16x16x32_bf16 v[84:87], v[144:147], v[36:39], v[84:87]
    v_mfma_f32_16x16x32_bf16 v[68:71], v[148:151], v[40:43], v[68:71]
    v_mfma_f32_16x16x32_bf16 v[72:75], v[152:155], v[40:43], v[72:75]
    v_mfma_f32_16x16x32_bf16 v[76:79], v[156:159], v[40:43], v[76:79]
    v_mfma_f32_16x16x32_bf16 v[80:83], v[160:163], v[40:43], v[80:83]
    v_mfma_f32_16x16x32_bf16 v[84:87], v[164:167], v[40:43], v[84:87]
    v_mfma_f32_16x16x32_bf16 v[68:71], v[168:171], v[44:47], v[68:71]
    s_waitcnt lgkmcnt(0)
    v_mfma_f32_16x16x32_bf16 v[72:75], v[88:91], v[44:47], v[72:75]
    v_mfma_f32_16x16x32_bf16 v[76:79], v[92:95], v[44:47], v[76:79]
    v_mfma_f32_16x16x32_bf16 v[80:83], v[96:99], v[44:47], v[80:83]
    v_mfma_f32_16x16x32_bf16 v[84:87], v[100:103], v[44:47], v[84:87]
FL_n0:
    s_bitcmp1_b32 s56, 1
    s_cbranch_scc0 FL_n1
    s_waitcnt vmcnt(0)
    v_max3_u32 v1, v48, v52, v56
    v_max3_u32 v1, v1, v60, v64
    v_max_u32 v1, v1, v66
    v_cmp_eq_u32 vcc, -1, v1
    s_and_b64 vcc, vcc, s[60:61]
    s_cbranch_scc1 FL_n1
    s_bitset0_b32 s56, 1

    v_cmp_eq_u32 vcc, -1, v25
    s_or_b32 s3, s96, s45
    s_and_b32 vcc_lo, vcc_lo, 0x3ff
    s_or_b32 s3, s3, vcc_lo
    s_cbranch_scc1 F_nbr
    s_mov_b32 s96, 1
    s_add_u32 m0, s55, 0
    s_nop 0
    buffer_load_dwordx4 v6, s[40:43], s52 offen  lds
    s_add_u32 m0, s55, 1024
    s_nop 0
    buffer_load_dwordx4 v6, s[40:43], s53 offen  lds
    s_add_u32 m0, s55, 2048
    s_mov_b32 exec_hi, 0
    buffer_load_dwordx4 v6, s[40:43], s98 offen  lds
    s_mov_b32 exec_hi, -1
F_nbr:
    v_mfma_f32_16x16x32_bf16 v[68:71], v[172:175], v[48:51], v[68:71]
    v_mfma_f32_16x16x32_bf16 v[72:75], v[176:179], v[48:51], v[72:75]
    v_mfma_f32_16x16x32_bf16 v[76:79], v[180:183], v[48:51], v[76:79]
    ds_read_b64_tr_b16 v[172:173], v27 offset:25600
    ds_read_b64_tr_b16 v[174:175], v27 offset:38400
    v_mfma_f32_16x16x32_bf16 v[80:83], v[184:187], v[48:51], v[80:83]
    ds_read_b64_tr_b16 v[176:177], v10 offset:25664
    ds_read_b64_tr_b16 v[178:179], v10 offset:38464
    v_mfma_f32_16x16x32_bf16 v[84:87], v[188:191], v[48:51], v[84:87]
    ds_read_b64_tr_b16 v[180:181], v27 offset:25664
    ds_read_b64_tr_b16 v[182:183], v27 offset:38464
    v_mfma_f32_16x16x32_bf16 v[68:71], v[192:195], v[52:55], v[68:71]
    ds_read_b64_tr_b16 v[184:185], v11 offset:25728
    ds_read_b64_tr_b16 v[186:187], v11 offset:38528
    v_mfma_f32_16x16x32_bf16 v[72:75], v[196:199], v[52:55], v[72:75]
    v_mfma_f32_16x16x32_bf16 v[76:79], v[200:203], v[52:55], v[76:79]
    v_mfma_f32_16x16x32_bf16 v[80:83], v[204:207], v[52:55], v[80:83]
    v_mfma_f32_16x16x32_bf16 v[84:87], v[208:211], v[52:55], v[84:87]
    v_mfma_f32_16x16x32_bf16 v[68:71], v[212:215], v[56:59], v[68:71]
    v_mfma_f32_16x16x32_bf16 v[72:75], v[216:219], v[56:59], v[72:75]
    v_mfma_f32_16x16x32_bf16 v[76:79], v[220:223], v[56:59], v[76:79]
    v_mfma_f32_16x16x32_bf16 v[80:83], v[224:227], v[56:59], v[80:83]
    v_mfma_f32_16x16x32_bf16 v[84:87], v[228:231], v[56:59], v[84:87]
    v_mfma_f32_16x16x32_bf16 v[68:71], v[232:235], v[60:63], v[68:71]
    v_mfma_f32_16x16x32_bf16 v[72:75], v[236:239], v[60:63], v[72:75]
    v_mfma_f32_16x16x32_bf16 v[76:79], v[240:243], v[60:63], v[76:79]
    v_mfma_f32_16x16x32_bf16 v[80:83], v[244:247], v[60:63], v[80:83]
    v_mfma_f32_16x16x32_bf16 v[84:87], v[248:251], v[60:63], v[84:87]
    v_mfma_f32_16x16x32_bf16 v[68:71], v[252:255], v[64:67], v[68:71]
    s_waitcnt lgkmcnt(0)
    v_mfma_f32_16x16x32_bf16 v[72:75], v[172:175], v[64:67], v[72:75]
    v_mfma_f32_16x16x32_bf16 v[76:79], v[176:179], v[64:67], v[76:79]
    v_mfma_f32_16x16x32_bf16 v[80:83], v[180:183], v[64:67], v[80:83]
    v_mfma_f32_16x16x32_bf16 v[84:87], v[184:187], v[64:67], v[84:87]
FL_n1:
    s_cmp_eq_u32 s56, 0
    s_cbranch_scc1 FL_done
    s_bitcmp1_b32 s56, 0
    s_cbranch_scc0 FL_r1

    buffer_load_dwordx2 v[44:45], v5, s[40:43], s47 offen offset:2048 sc1
    buffer_load_dwordx4 v[28:31], v4, s[40:43], s47 offen sc1
    buffer_load_dwordx4 v[32:35], v4, s[40:43], s47 offen offset:1024 sc1
    buffer_load_dwordx2 v[46:47], v5, s[40:43], s48 offen offset:2048 sc1
    buffer_load_dwordx4 v[36:39], v4, s[40:43], s48 offen sc1
    buffer_load_dwordx4 v[40:43], v4, s[40:43], s48 offen offset:1024 sc1
FL_r1:
    s_bitcmp1_b32 s56, 1
    s_cbranch_scc0 FL_r2
    buffer_load_dwordx2 v[64:65], v5, s[40:43], s49 offen offset:2048 sc1
    buffer_load_dwordx4 v[48:51], v4, s[40:43], s49 offen sc1
    buffer_load_dwordx4 v[52:55], v4, s[40:43], s49 offen offset:1024 sc1
    buffer_load_dwordx2 v[66:67], v5, s[40:43], s50 offen offset:2048 sc1
    buffer_load_dwordx4 v[56:59], v4, s[40:43], s50 offen sc1
    buffer_load_dwordx4 v[60:63], v4, s[40:43], s50 offen offset:1024 sc1
FL_r2:
    s_add_u32 s57, s57, 1
    s_cmp_lt_u32 s57, 16384
    s_cselect_b64 s[60:61], -1, 0
    s_waitcnt vmcnt(0)
    s_branch FL_loop
FL_done:

    v_cmp_eq_u32 vcc, -1, v26
    s_cbranch_vccnz F_gw
F_gok:
    s_cmp_lg_u32 s45, 0
    s_cbranch_scc1 F_hi
    s_cmp_lg_u32 s96, 0
    s_cbranch_scc1 F_bin
    s_mov_b32 s57, 0
    s_mov_b64 exec, 0x3ff
F_bw:
    buffer_load_dword v25, v20, s[40:43], 0 offen sc1
    s_add_u32 s57, s57, 1
    s_cmp_lt_u32 s57, 16384
    s_waitcnt vmcnt(0)
    s_cbranch_scc0 F_bok
    v_cmp_eq_u32 vcc, -1, v25
    s_cbranch_vccnz F_bw
F_bok:
    s_mov_b64 exec, -1

    s_add_u32 m0, s55, 0
    s_nop 0
    buffer_load_dwordx4 v6, s[40:43], s52 offen  lds
    s_add_u32 m0, s55, 1024
    s_nop 0
    buffer_load_dwordx4 v6, s[40:43], s53 offen  lds
    s_add_u32 m0, s55, 2048
    s_mov_b32 exec_hi, 0
    buffer_load_dwordx4 v6, s[40:43], s98 offen  lds
    s_mov_b32 exec_hi, -1
F_bin:
    s_waitcnt vmcnt(0)
    ds_read_b64_tr_b16 v[16:17], v12
    ds_read_b64_tr_b16 v[18:19], v13
    ds_read_b64_tr_b16 v[20:21], v12 offset:1024
    ds_read_b64_tr_b16 v[22:23], v13 offset:1024
    ds_read_b64_tr_b16 v[24:25], v14 offset:2048

    s_waitcnt lgkmcnt(4)
    v_lshlrev_b32 v40, 16, v16
    v_and_b32 v41, 0xffff0000, v16
    v_lshlrev_b32 v42, 16, v17
    v_and_b32 v43, 0xffff0000, v17
    v_sub_f32 v68, v68, v40
    v_sub_f32 v69, v69, v41
    v_sub_f32 v70, v70, v42
    v_sub_f32 v71, v71, v43
    v_fmac_f32 v40, v68, v26
    v_fmac_f32 v41, v69, v26
    v_fmac_f32 v42, v70, v26
    v_fmac_f32 v43, v71, v26
    ds_write_b128 v15, v[40:43] offset:3072
    s_waitcnt lgkmcnt(4)
    v_lshlrev_b32 v44, 16, v18
    v_and_b32 v45, 0xffff0000, v18
    v_lshlrev_b32 v46, 16, v19
    v_and_b32 v47, 0xffff0000, v19
    v_sub_f32 v72, v72, v44
    v_sub_f32 v73, v73, v45
    v_sub_f32 v74, v74, v46
    v_sub_f32 v75, v75, v47
    v_fmac_f32 v44, v72, v26
    v_fmac_f32 v45, v73, v26
    v_fmac_f32 v46, v74, v26
    v_fmac_f32 v47, v75, v26
    ds_write_b128 v15, v[44:47] offset:4096
    s_waitcnt lgkmcnt(4)
    v_lshlrev_b32 v48, 16, v20
    v_and_b32 v49, 0xffff0000, v20
    v_lshlrev_b32 v50, 16, v21
    v_and_b32 v51, 0xffff0000, v21
    v_sub_f32 v76, v76, v48
    v_sub_f32 v77, v77, v49
    v_sub_f32 v78, v78, v50
    v_sub_f32 v79, v79, v51
    v_fmac_f32 v48, v76, v26
    v_fmac_f32 v49, v77, v26
    v_fmac_f32 v50, v78, v26
    v_fmac_f32 v51, v79, v26
    ds_write_b128 v15, v[48:51] offset:5120
    s_waitcnt lgkmcnt(4)
    v_lshlrev_b32 v52, 16, v22
    v_and_b32 v53, 0xffff0000, v22
    v_lshlrev_b32 v54, 16, v23
    v_and_b32 v55, 0xffff0000, v23
    v_sub_f32 v80, v80, v52
    v_sub_f32 v81, v81, v53
    v_sub_f32 v82, v82, v54
    v_sub_f32 v83, v83, v55
    v_fmac_f32 v52, v80, v26
    v_fmac_f32 v53, v81, v26
    v_fmac_f32 v54, v82, v26
    v_fmac_f32 v55, v83, v26
    ds_write_b128 v15, v[52:55] offset:6144
    s_waitcnt lgkmcnt(4)
    v_lshlrev_b32 v56, 16, v24
    v_and_b32 v57, 0xffff0000, v24
    v_lshlrev_b32 v58, 16, v25
    v_and_b32 v59, 0xffff0000, v25
    v_sub_f32 v84, v84, v56
    v_sub_f32 v85, v85, v57
    v_sub_f32 v86, v86, v58
    v_sub_f32 v87, v87, v59
    v_fmac_f32 v56, v84, v26
    v_fmac_f32 v57, v85, v26
    v_fmac_f32 v58, v86, v26
    v_fmac_f32 v59, v87, v26
    ds_write_b128 v15, v[56:59] offset:7168
    s_waitcnt lgkmcnt(0)
    s_barrier
    s_endpgm
F_hi:
    v_cmp_lt_u32 vcc, 1, v9
    s_barrier
    ds_read_b128 v[88:91], v15 offset:3072
    ds_read_b128 v[92:95], v15 offset:4096
    ds_read_b128 v[96:99], v15 offset:5120
    ds_read_b128 v[100:103], v15 offset:6144
    ds_read_b128 v[104:107], v15 offset:7168
    s_waitcnt lgkmcnt(4)
    v_fmac_f32 v88, v68, v26
    v_fmac_f32 v89, v69, v26
    v_fmac_f32 v90, v70, v26
    v_fmac_f32 v91, v71, v26
    v_cvt_pk_bf16_f32 v28, v88, v89
    v_cvt_pk_bf16_f32 v29, v90, v91
    s_waitcnt lgkmcnt(3)
    v_fmac_f32 v92, v72, v26
    v_fmac_f32 v93, v73, v26
    v_fmac_f32 v94, v74, v26
    v_fmac_f32 v95, v75, v26
    v_cvt_pk_bf16_f32 v30, v92, v93
    v_cvt_pk_bf16_f32 v31, v94, v95
    v_cndmask_b32 v40, v28, v30, vcc
    v_cndmask_b32 v41, v29, v31, vcc
    v_cndmask_b32 v42, v30, v28, vcc
    v_cndmask_b32 v43, v31, v29, vcc
    buffer_store_dwordx4 v[40:43], v16, s[36:39], s46 offen offset:0
    s_waitcnt lgkmcnt(2)
    v_fmac_f32 v96, v76, v26
    v_fmac_f32 v97, v77, v26
    v_fmac_f32 v98, v78, v26
    v_fmac_f32 v99, v79, v26
    v_cvt_pk_bf16_f32 v32, v96, v97
    v_cvt_pk_bf16_f32 v33, v98, v99
    s_waitcnt lgkmcnt(1)
    v_fmac_f32 v100, v80, v26
    v_fmac_f32 v101, v81, v26
    v_fmac_f32 v102, v82, v26
    v_fmac_f32 v103, v83, v26
    v_cvt_pk_bf16_f32 v34, v100, v101
    v_cvt_pk_bf16_f32 v35, v102, v103
    v_cndmask_b32 v44, v32, v34, vcc
    v_cndmask_b32 v45, v33, v35, vcc
    v_cndmask_b32 v46, v34, v32, vcc
    v_cndmask_b32 v47, v35, v33, vcc
    buffer_store_dwordx4 v[44:47], v16, s[36:39], s46 offen offset:64
    s_waitcnt lgkmcnt(0)
    v_fmac_f32 v104, v84, v26
    v_fmac_f32 v105, v85, v26
    v_fmac_f32 v106, v86, v26
    v_fmac_f32 v107, v87, v26
    v_cvt_pk_bf16_f32 v36, v104, v105
    v_cvt_pk_bf16_f32 v37, v106, v107
    buffer_store_dwordx2 v[36:37], v17, s[36:39], s46 offen offset:128
    s_endpgm
F_gw:
    s_sleep 8
    buffer_load_dword v26, v21, s[40:43], s54 offen sc1
    s_add_u32 s57, s57, 1
    s_cmp_ge_u32 s57, 16384
    s_waitcnt vmcnt(0)
    s_cbranch_scc1 F_gok
    v_cmp_eq_u32 vcc, -1, v26
    s_cbranch_vccnz F_gw
    s_branch F_gok

K_end:
    s_endpgm
.section .rodata,"a"
.p2align 6
.amdhsa_kernel gated_mix__linear_attn_block__ssm_conv_s4d__prompt_kernel
  .amdhsa_next_free_vgpr 256
  .amdhsa_next_free_sgpr 102
  .amdhsa_accum_offset 256
  .amdhsa_group_segment_fixed_size 0
  .amdhsa_kernarg_size 112
  .amdhsa_user_sgpr_count 2
  .amdhsa_user_sgpr_kernarg_segment_ptr 1
  .amdhsa_system_sgpr_workgroup_id_x 1
  .amdhsa_float_denorm_mode_32 3
.end_amdhsa_kernel
```
